```python
import torch

def _softmax(x, axis=-1):
    return torch.softmax(x, dim=axis)
def _gelu(x):
    return torch.nn.functional.gelu(x, approximate="tanh")
def _silu(x):
    return torch.nn.functional.silu(x)
def _sigmoid(x):
    return torch.sigmoid(x)
def _layernorm(x, axis=-1, eps=1e-5):
    m = x.mean(dim=axis, keepdim=True)
    v = x.var(dim=axis, keepdim=True, unbiased=False)
    return (x - m) / torch.sqrt(v + eps)
def _scatter_add(tgt, idx, src, axis=0):
    return tgt.clone().index_add_(axis, idx, src)
def _segment_sum(src, seg, n):
    out = torch.zeros((n,) + src.shape[1:], dtype=src.dtype)
    return out.index_add_(0, seg, src)
def _pad(x, pw):
    flat = tuple(v for pair in reversed(pw) for v in pair)
    return torch.nn.functional.pad(x, flat)

kernel_name = 'parallel_sum__grouped_kv_mqa__geglu_ffn__prompt'

def setup_inputs():

    _w = (lambda a: (lambda t: t.to(torch.bfloat16) if t.is_floating_point() else t)(torch.as_tensor(a)))
    def _A_setup():
        B, S, D, H = 1, 2048, 640, 32
        Dh = D // H
        return {
            "x": _w((lambda *s: torch.randn(*s, dtype=torch.bfloat16) * 0.05)(B, S, D)),
            "wq": _w((lambda *s: torch.randn(*s, dtype=torch.bfloat16) * 0.2)(D, H * Dh)),
            "wk": _w((lambda *s: torch.randn(*s, dtype=torch.bfloat16) * 0.2)(D, Dh)),
            "wv": _w((lambda *s: torch.randn(*s, dtype=torch.bfloat16) * 0.1)(D, Dh)),
            "wo": _w((lambda *s: torch.randn(*s, dtype=torch.bfloat16) * 0.1)(H * Dh, D)),
        }
    _A_in = _A_setup()

    def _B_setup():
        B, S, D, F = 1, 2048, 640, 1728
        return {
            "x": _w((lambda *s: torch.randn(*s, dtype=torch.bfloat16) * 0.05)(B, S, D)),
            "w_gate": _w((lambda *s: torch.randn(*s, dtype=torch.bfloat16) * 0.1)(D, F)),
            "w_up": _w((lambda *s: torch.randn(*s, dtype=torch.bfloat16) * 0.1)(D, F)),
            "w_down": _w((lambda *s: torch.randn(*s, dtype=torch.bfloat16) * 0.1)(F, D)),
        }
    _B_in = _B_setup()

    return {
        "A_x": _A_in["x"],
        "A_wq": _A_in["wq"],
        "A_wk": _A_in["wk"],
        "A_wv": _A_in["wv"],
        "A_wo": _A_in["wo"],
        "B_x": _B_in["x"],
        "B_w_gate": _B_in["w_gate"],
        "B_w_up": _B_in["w_up"],
        "B_w_down": _B_in["w_down"],
    }

def reference(A_x, A_wq, A_wk, A_wv, A_wo, B_x, B_w_gate, B_w_up, B_w_down):
    def _A_ref(x, wq, wk, wv, wo):
        B, S, D = x.shape
        H = 32
        Dh = D // H
        q = (lambda x, *d: x.permute(*d))((x @ wq).reshape(B, S, H, Dh), 0, 2, 1, 3)
        k = x @ wk
        v = x @ wv
        scores = torch.einsum("bhqd,bkd->bhqk", q, k) * (Dh ** -0.5)
        p = _softmax(scores, axis=-1)
        o = torch.einsum("bhqk,bkd->bhqd", p, v)
        return (lambda x, *d: x.permute(*d))(o, 0, 2, 1, 3).reshape(B, S, H * Dh) @ wo

    def _B_ref(x, w_gate, w_up, w_down):
        return (_gelu(x @ w_gate) * (x @ w_up)) @ w_down

    x = A_x
    xn = _layernorm(x, axis=-1)
    return x + _A_ref(xn, A_wq, A_wk, A_wv, A_wo) + _B_ref(xn, B_w_gate, B_w_up, B_w_down)
```

```asm
; @launch grid=(256,1,1) block=(768,1,1) lds=163840
.amdgcn_target "amdgcn-amd-amdhsa--gfx950"
.text
.globl parallel_sum__grouped_kv_mqa__geglu_ffn__prompt_kernel
.p2align 8
.type parallel_sum__grouped_kv_mqa__geglu_ffn__prompt_kernel,@function
parallel_sum__grouped_kv_mqa__geglu_ffn__prompt_kernel:
    s_cmp_ge_u32 s2, 256
    s_cbranch_scc1 end_1
    s_load_dwordx8 s[68:75], s[0:1], 0
    s_load_dwordx4 s[80:83], s[0:1], 48
    s_load_dwordx4 s[76:79], s[0:1], 80
    s_load_dwordx2 s[84:85], s[0:1], 32
    s_load_dwordx4 s[88:91], s[0:1], 64
    v_lshrrev_b32 v4, 6, v0
    v_and_b32 v1, 63, v0
    v_readfirstlane_b32 s24, v4
    v_lshrrev_b32 v2, 5, v1
    v_and_b32 v3, 31, v1
    s_cmp_lg_u32 s24, 11
    s_cbranch_scc1 nowarm_3
    s_getpc_b64 s[4:5]
pc_4:
    s_bfe_u32 s44, s2, 0x30003
    s_lshl_b32 s44, s44, 13
    v_lshl_add_u32 v4, v1, 7, s44
    v_min_u32 v4, end_1-pc_4, v4
    global_load_dword v165, v4, s[4:5]
nowarm_3:
    s_bfe_u32 s27, s2, 0x30003
    s_and_b32 s46, s2, 1
    s_lshl_b32 s46, s46, 3
    s_add_u32 s27, s27, s46
    s_bfe_u32 s46, s2, 0x20001
    s_xor_b32 s46, s46, 0
    s_lshl_b32 s46, s46, 2
    s_lshr_b32 s47, s2, 6
    s_add_u32 s28, s46, s47
    s_cmp_ge_u32 s28, 11
    s_cselect_b32 s48, 1, 0
    s_sub_u32 s44, s28, 11
    s_lshl_b32 s45, s44, 6
    s_add_u32 s45, s45, 1408
    s_lshl_b32 s46, s28, 7
    s_lshl_b32 s50, s44, 7
    s_cmp_eq_u32 s48, 1
    s_cselect_b32 s49, s45, s46
    s_and_b32 s25, s24, 1
    s_lshr_b32 s26, s24, 1
    s_sub_u32 s44, s24, 8
    s_cmp_ge_u32 s24, 8
    s_cselect_b32 s26, s44, s26
    s_and_b32 s44, s26, 1
    s_and_b32 s51, s44, s48
    s_lshr_b32 s43, s26, 1
    s_andn2_b32 s46, s44, s48
    s_lshl_b32 s46, s46, 6
    s_add_u32 s46, s46, s49
    s_lshl_b32 s47, s43, 6
    s_add_u32 s47, s47, s50
    s_mov_b32 s53, 3456
    s_cmp_eq_u32 s51, 1
    s_cselect_b32 s52, s47, s46
    s_cselect_b32 s53, 1280, s53
    s_lshl_b32 s52, s52, 1
    s_lshl_b32 s31, s53, 3
    s_lshl_b32 s32, s53, 6
    v_lshrrev_b32 v4, 3, v1
    v_and_b32 v5, 7, v1
    s_lshl_b32 s44, s27, 7
    s_lshl_b32 s45, s26, 5
    s_add_u32 s44, s44, s45
    v_add_u32 v6, s44, v4
    v_mul_u32_u24 v6, 1280, v6
    v_lshrrev_b32 v7, 1, v4
    v_xor_b32 v7, v7, v5
    v_lshl_add_u32 v20, v7, 4, v6
    v_xor_b32 v7, 4, v7
    v_lshl_add_u32 v21, v7, 4, v6
    v_add_u32 v21, 10240, v21
    v_mul_lo_u32 v6, v4, s53
    v_lshrrev_b32 v7, 1, v5
    v_and_b32 v8, 2, v4
    v_xor_b32 v7, v7, v8
    v_and_b32 v8, 1, v5
    v_lshl_add_u32 v6, v8, 4, v6
    v_add_u32 v6, s52, v6
    v_lshl_add_u32 v22, v7, 5, v6
    v_xor_b32 v7, 1, v7
    v_lshl_add_u32 v23, v7, 5, v6
    s_lshl_b32 s36, s26, 12
    s_mul_i32 s37, s26, 24576
    s_add_u32 s37, s37, 49152
    s_lshl_b32 s33, s53, 5
    s_mul_i32 s33, s33, s25
    s_lshl_b32 s44, s25, 12
    s_add_u32 s35, s37, s44
    s_bfe_u32 s44, s2, 0x30003
    s_lshr_b32 s45, s2, 6
    s_add_u32 s44, s44, s45
    s_and_b32 s100, s44, 1
    s_xor_b32 s45, s100, 1
    s_mul_i32 s38, s100, s32
    s_mul_i32 s39, s45, s32
    s_mov_b32 s10, 2621440
    s_mov_b32 s11, 0x20000
    s_mov_b32 s14, 2211840
    s_mov_b32 s15, 0x20000
    s_cmp_ge_u32 s24, 8
    s_cbranch_scc1 aux_2
    s_cmp_eq_u32 s43, 1
    s_waitcnt lgkmcnt(0)
    s_cselect_b32 s12, s82, s80
    s_cselect_b32 s13, s83, s81
    s_cmp_eq_u32 s51, 1
    s_cselect_b32 s12, s70, s12
    s_cselect_b32 s13, s71, s13
    s_cselect_b32 s14, 819200, s14
    s_add_u32 m0, s35, 0
    s_add_u32 s34, s33, s38
    buffer_load_dwordx4 v22, s[12:15], s34 offen lds
    s_add_u32 s33, s33, s31
    s_add_u32 m0, s35, 1024
    s_add_u32 s34, s33, s38
    buffer_load_dwordx4 v23, s[12:15], s34 offen lds
    s_add_u32 s33, s33, s31
    s_add_u32 m0, s35, 2048
    s_add_u32 s34, s33, s38
    buffer_load_dwordx4 v22, s[12:15], s34 offen lds
    s_add_u32 s33, s33, s31
    s_add_u32 m0, s35, 3072
    s_add_u32 s34, s33, s38
    buffer_load_dwordx4 v23, s[12:15], s34 offen lds
    s_mul_i32 s44, s31, 3
    s_sub_u32 s33, s33, s44
    s_mov_b32 s8, s68
    s_mov_b32 s9, s69
    s_mov_b32 s16, s72
    s_mov_b32 s17, s73
    s_mov_b32 s18, 25600
    s_mov_b32 s19, 0x20000
    v_mov_b32 v24, 0
    s_branch common_5
aux_2:
    s_setprio 3
    s_cmp_lt_u32 s28, 8
    s_cselect_b32 s54, 1, 0
    s_cmp_lt_u32 s26, 3
    s_cselect_b32 s40, s54, 0
    s_lshl_b32 s44, s26, 10
    s_add_u32 s38, s44, 147456
    v_lshl_add_u32 v24, v1, 4, s44
    s_mov_b32 s18, 25600
    s_mov_b32 s19, 0x20000
    s_lshl_b32 s46, s100, 7
    s_lshl_b32 s57, s45, 7
    s_mul_i32 s58, s100, 2560
    s_mul_i32 s59, s45, 2560
    s_bitcmp1_b32 s28, 2
    s_waitcnt lgkmcnt(0)
    s_mov_b32 s8, s68
    s_mov_b32 s9, s69
    s_cselect_b32 s16, s74, s72
    s_cselect_b32 s17, s75, s73
    s_add_u32 m0, s36, 0
    s_add_u32 s34, s46, 0
    buffer_load_dwordx4 v20, s[8:11], s34 offen lds
    s_add_u32 m0, s36, 1024
    s_add_u32 s34, s46, 0
    buffer_load_dwordx4 v21, s[8:11], s34 offen lds
    s_add_u32 m0, s36, 2048
    s_add_u32 s34, s46, 20480
    buffer_load_dwordx4 v20, s[8:11], s34 offen lds
    s_add_u32 m0, s36, 3072
    s_add_u32 s34, s46, 20480
    buffer_load_dwordx4 v21, s[8:11], s34 offen lds
    s_cmp_eq_u32 s40, 0
    s_cbranch_scc1 nokv_6
    s_add_u32 m0, s38, 0
    s_nop 0
    buffer_load_dwordx4 v24, s[16:19], s58 offen lds
nokv_6:
    s_cmp_eq_u32 s43, 1
    s_cselect_b32 s12, s82, s80
    s_cselect_b32 s13, s83, s81
    s_cmp_eq_u32 s51, 1
    s_cselect_b32 s12, s70, s12
    s_cselect_b32 s13, s71, s13
    s_cselect_b32 s14, 819200, s14
common_5:
    s_mov_b32 s62, 0
    s_mov_b32 s63, -1
    s_and_b32 s44, s2, 7
    s_lshl_b32 s44, s44, 2
    s_bfe_u32 s46, s2, 0x20003
    s_add_u32 s29, s44, s46
    s_lshr_b32 s30, s2, 5
    s_mov_b32 s20, s78
    s_mov_b32 s21, s79
    s_mov_b32 s22, 19267584
    s_mov_b32 s23, 0x20000
    s_mov_b32 s64, s90
    s_mov_b32 s65, s91
    s_mov_b32 s66, 2621440
    s_mov_b32 s67, 0x20000
    s_cmp_ge_u32 s24, 8
    s_cbranch_scc1 aux2_7
    s_mov_b32 s4, s76
    s_mov_b32 s5, s77
    s_mov_b32 s6, 256
    s_mov_b32 s7, 0x20000
    s_lshr_b32 s44, s30, 2
    s_lshl_b32 s46, s29, 1
    s_add_u32 s46, s46, s44
    s_and_b32 s44, s30, 3
    s_lshl_b32 s44, s44, 3
    s_add_u32 s45, s44, s24
    s_mul_i32 s37, s46, 40960
    s_add_u32 s37, s37, 11534336
    s_lshl_b32 s36, s45, 10
    s_add_u32 s36, s36, s37
    s_lshl_b32 s44, s45, 8
    s_add_u32 s37, s37, s44
    s_add_u32 s37, s37, 32768
    v_and_b32 v4, 15, v1
    v_lshrrev_b32 v5, 4, v1
    v_lshrrev_b32 v6, 1, v4
    v_xor_b32 v6, v6, v5
    v_lshlrev_b32 v4, 7, v4
    s_lshl_b32 s44, s25, 13
    v_add_u32 v4, s44, v4
    v_lshl_add_u32 v124, v6, 4, v4
    v_xor_b32 v6, 4, v6
    v_lshl_add_u32 v125, v6, 4, v4
    v_bfe_u32 v6, v1, 2, 2
    v_lshl_add_u32 v4, v5, 3, v6
    v_lshlrev_b32 v4, 7, v4
    v_and_b32 v7, 3, v1
    v_lshl_add_u32 v4, v7, 3, v4
    v_and_b32 v6, 2, v6
    v_and_b32 v5, 1, v5
    v_xor_b32 v5, v5, v6
    s_lshr_b32 s44, s26, 1
    s_and_b32 s57, s44, s48
    s_lshl_b32 s44, s26, 1
    s_add_u32 s45, s44, 0
    s_and_b32 s46, s45, 3
    s_lshr_b32 s45, s45, 2
    s_add_u32 s45, s45, 0
    s_sub_u32 s44, s44, 3
    s_cmp_eq_u32 s57, 1
    s_cselect_b32 s45, s44, s45
    s_cselect_b32 s46, 0, s46
    s_mul_i32 s45, s45, 24576
    s_add_u32 s45, s45, 49152
    v_xor_b32 v6, s46, v5
    v_lshl_add_u32 v6, v6, 5, v4
    v_add_u32 v126, s45, v6
    s_lshl_b32 s44, s26, 1
    s_add_u32 s45, s44, 0
    s_and_b32 s46, s45, 3
    s_lshr_b32 s45, s45, 2
    s_add_u32 s45, s45, 2
    s_sub_u32 s44, s44, 3
    s_cmp_eq_u32 s57, 1
    s_cselect_b32 s45, s44, s45
    s_cselect_b32 s46, 1, s46
    s_mul_i32 s45, s45, 24576
    s_add_u32 s45, s45, 49152
    v_xor_b32 v6, s46, v5
    v_lshl_add_u32 v6, v6, 5, v4
    v_add_u32 v127, s45, v6
    s_lshl_b32 s44, s26, 1
    s_add_u32 s45, s44, 1
    s_and_b32 s46, s45, 3
    s_lshr_b32 s45, s45, 2
    s_add_u32 s45, s45, 0
    s_sub_u32 s44, s44, 3
    s_cmp_eq_u32 s57, 1
    s_cselect_b32 s45, s44, s45
    s_cselect_b32 s46, 2, s46
    s_mul_i32 s45, s45, 24576
    s_add_u32 s45, s45, 49152
    v_xor_b32 v6, s46, v5
    v_lshl_add_u32 v6, v6, 5, v4
    v_add_u32 v128, s45, v6
    s_lshl_b32 s44, s26, 1
    s_add_u32 s45, s44, 1
    s_and_b32 s46, s45, 3
    s_lshr_b32 s45, s45, 2
    s_add_u32 s45, s45, 2
    s_sub_u32 s44, s44, 3
    s_cmp_eq_u32 s57, 1
    s_cselect_b32 s45, s44, s45
    s_cselect_b32 s46, 3, s46
    s_mul_i32 s45, s45, 24576
    s_add_u32 s45, s45, 49152
    v_xor_b32 v6, s46, v5
    v_lshl_add_u32 v6, v6, 5, v4
    v_add_u32 v129, s45, v6
    s_add_u32 m0, s35, 8192
    s_add_u32 s34, s33, s39
    buffer_load_dwordx4 v22, s[12:15], s34 offen lds
    s_add_u32 s33, s33, s31
    s_add_u32 m0, s35, 9216
    s_add_u32 s34, s33, s39
    buffer_load_dwordx4 v23, s[12:15], s34 offen lds
    s_add_u32 s33, s33, s31
    s_add_u32 m0, s35, 10240
    s_add_u32 s34, s33, s39
    buffer_load_dwordx4 v22, s[12:15], s34 offen lds
    s_add_u32 s33, s33, s31
    s_add_u32 m0, s35, 11264
    s_add_u32 s34, s33, s39
    buffer_load_dwordx4 v23, s[12:15], s34 offen lds
    s_cmp_eq_u32 s25, 1
    s_cbranch_scc1 rowv_8
    s_waitcnt vmcnt(4)
    s_barrier
    ds_read_b64_tr_b16 v[108:109], v126 offset:0
    ds_read_b64_tr_b16 v[110:111], v126 offset:512
    ds_read_b128 v[76:79], v124 offset:0
    ds_read_b128 v[80:83], v124 offset:2048
    ds_read_b128 v[84:87], v124 offset:4096
    ds_read_b128 v[88:91], v124 offset:6144
    ds_read_b64_tr_b16 v[112:113], v127 offset:0
    ds_read_b64_tr_b16 v[114:115], v127 offset:512
    ds_read_b64_tr_b16 v[116:117], v128 offset:0
    ds_read_b64_tr_b16 v[118:119], v128 offset:512
    ds_read_b64_tr_b16 v[120:121], v129 offset:0
    ds_read_b64_tr_b16 v[122:123], v129 offset:512
    s_waitcnt lgkmcnt(6)
    v_mfma_f32_16x16x32_bf16 v[12:15], v[108:111], v[76:79], 0
    v_mfma_f32_16x16x32_bf16 v[16:19], v[108:111], v[80:83], 0
    s_mul_i32 s44, s27, 40
    v_mfma_f32_16x16x32_bf16 v[20:23], v[108:111], v[84:87], 0
    v_mfma_f32_16x16x32_bf16 v[24:27], v[108:111], v[88:91], 0
    v_lshrrev_b32 v164, 3, v1
    s_waitcnt lgkmcnt(4)
    v_mfma_f32_16x16x32_bf16 v[28:31], v[112:115], v[76:79], 0
    ds_read_b64_tr_b16 v[108:109], v126 offset:4096
    ds_read_b64_tr_b16 v[110:111], v126 offset:4608
    v_add_u32 v164, s44, v164
    v_mfma_f32_16x16x32_bf16 v[32:35], v[112:115], v[80:83], 0
    ds_read_b128 v[92:95], v125 offset:0
    ds_read_b128 v[96:99], v125 offset:2048
    v_mfma_f32_16x16x32_bf16 v[36:39], v[112:115], v[84:87], 0
    ds_read_b128 v[100:103], v125 offset:4096
    ds_read_b128 v[104:107], v125 offset:6144
    v_mul_lo_u32 v165, v164, s53
    v_mfma_f32_16x16x32_bf16 v[40:43], v[112:115], v[88:91], 0
    ds_read_b64_tr_b16 v[112:113], v127 offset:4096
    ds_read_b64_tr_b16 v[114:115], v127 offset:4608
    s_waitcnt lgkmcnt(10)
    v_mfma_f32_16x16x32_bf16 v[44:47], v[116:119], v[76:79], 0
    v_and_b32 v164, 7, v1
    v_mfma_f32_16x16x32_bf16 v[48:51], v[116:119], v[80:83], 0
    v_lshl_add_u32 v165, v164, 4, v165
    v_mfma_f32_16x16x32_bf16 v[52:55], v[116:119], v[84:87], 0
    v_mfma_f32_16x16x32_bf16 v[56:59], v[116:119], v[88:91], 0
    ds_read_b64_tr_b16 v[116:117], v128 offset:4096
    ds_read_b64_tr_b16 v[118:119], v128 offset:4608
    s_mov_b32 s47, s52
    s_waitcnt lgkmcnt(10)
    v_mfma_f32_16x16x32_bf16 v[60:63], v[120:123], v[76:79], 0
    v_mfma_f32_16x16x32_bf16 v[64:67], v[120:123], v[80:83], 0
    buffer_load_dwordx4 v[132:135], v165, s[12:15], s47 offen
    s_add_u32 s47, s47, s31
    v_mfma_f32_16x16x32_bf16 v[68:71], v[120:123], v[84:87], 0
    buffer_load_dwordx4 v[136:139], v165, s[12:15], s47 offen
    s_add_u32 s47, s47, s31
    v_mfma_f32_16x16x32_bf16 v[72:75], v[120:123], v[88:91], 0
    ds_read_b64_tr_b16 v[120:121], v129 offset:4096
    ds_read_b64_tr_b16 v[122:123], v129 offset:4608
    s_waitcnt lgkmcnt(6)
    v_mfma_f32_16x16x32_bf16 v[12:15], v[108:111], v[92:95], v[12:15]
    buffer_load_dwordx4 v[140:143], v165, s[12:15], s47 offen
    s_add_u32 s47, s47, s31
    v_mfma_f32_16x16x32_bf16 v[16:19], v[108:111], v[96:99], v[16:19]
    v_mfma_f32_16x16x32_bf16 v[20:23], v[108:111], v[100:103], v[20:23]
    buffer_load_dwordx4 v[144:147], v165, s[12:15], s47 offen
    s_add_u32 s47, s47, s31
    v_mfma_f32_16x16x32_bf16 v[24:27], v[108:111], v[104:107], v[24:27]
    buffer_load_dwordx4 v[148:151], v165, s[12:15], s47 offen
    s_add_u32 s47, s47, s31
    s_waitcnt vmcnt(5)
    s_waitcnt lgkmcnt(0)
    s_barrier
    v_mfma_f32_16x16x32_bf16 v[28:31], v[112:115], v[92:95], v[28:31]
    ds_read_b64_tr_b16 v[108:109], v126 offset:8192
    ds_read_b64_tr_b16 v[110:111], v126 offset:8704
    v_mfma_f32_16x16x32_bf16 v[32:35], v[112:115], v[96:99], v[32:35]
    ds_read_b128 v[76:79], v124 offset:16384
    ds_read_b128 v[80:83], v124 offset:18432
    v_mfma_f32_16x16x32_bf16 v[36:39], v[112:115], v[100:103], v[36:39]
    ds_read_b128 v[84:87], v124 offset:20480
    ds_read_b128 v[88:91], v124 offset:22528
    v_mfma_f32_16x16x32_bf16 v[40:43], v[112:115], v[104:107], v[40:43]
    ds_read_b64_tr_b16 v[112:113], v127 offset:8192
    ds_read_b64_tr_b16 v[114:115], v127 offset:8704
    v_mfma_f32_16x16x32_bf16 v[44:47], v[116:119], v[92:95], v[44:47]
    v_mfma_f32_16x16x32_bf16 v[48:51], v[116:119], v[96:99], v[48:51]
    v_mfma_f32_16x16x32_bf16 v[52:55], v[116:119], v[100:103], v[52:55]
    v_mfma_f32_16x16x32_bf16 v[56:59], v[116:119], v[104:107], v[56:59]
    ds_read_b64_tr_b16 v[116:117], v128 offset:8192
    ds_read_b64_tr_b16 v[118:119], v128 offset:8704
    v_mfma_f32_16x16x32_bf16 v[60:63], v[120:123], v[92:95], v[60:63]
    v_mfma_f32_16x16x32_bf16 v[64:67], v[120:123], v[96:99], v[64:67]
    v_mfma_f32_16x16x32_bf16 v[68:71], v[120:123], v[100:103], v[68:71]
    v_mfma_f32_16x16x32_bf16 v[72:75], v[120:123], v[104:107], v[72:75]
    ds_read_b64_tr_b16 v[120:121], v129 offset:8192
    ds_read_b64_tr_b16 v[122:123], v129 offset:8704
    s_waitcnt lgkmcnt(6)
    v_mfma_f32_16x16x32_bf16 v[12:15], v[108:111], v[76:79], v[12:15]
    v_mfma_f32_16x16x32_bf16 v[16:19], v[108:111], v[80:83], v[16:19]
    v_mfma_f32_16x16x32_bf16 v[20:23], v[108:111], v[84:87], v[20:23]
    v_mfma_f32_16x16x32_bf16 v[24:27], v[108:111], v[88:91], v[24:27]
    s_waitcnt lgkmcnt(4)
    v_mfma_f32_16x16x32_bf16 v[28:31], v[112:115], v[76:79], v[28:31]
    ds_read_b64_tr_b16 v[108:109], v126 offset:12288
    ds_read_b64_tr_b16 v[110:111], v126 offset:12800
    v_mfma_f32_16x16x32_bf16 v[32:35], v[112:115], v[80:83], v[32:35]
    ds_read_b128 v[92:95], v125 offset:16384
    ds_read_b128 v[96:99], v125 offset:18432
    v_mfma_f32_16x16x32_bf16 v[36:39], v[112:115], v[84:87], v[36:39]
    ds_read_b128 v[100:103], v125 offset:20480
    ds_read_b128 v[104:107], v125 offset:22528
    v_mfma_f32_16x16x32_bf16 v[40:43], v[112:115], v[88:91], v[40:43]
    ds_read_b64_tr_b16 v[112:113], v127 offset:12288
    ds_read_b64_tr_b16 v[114:115], v127 offset:12800
    s_waitcnt lgkmcnt(10)
    v_mfma_f32_16x16x32_bf16 v[44:47], v[116:119], v[76:79], v[44:47]
    v_mfma_f32_16x16x32_bf16 v[48:51], v[116:119], v[80:83], v[48:51]
    v_mfma_f32_16x16x32_bf16 v[52:55], v[116:119], v[84:87], v[52:55]
    v_mfma_f32_16x16x32_bf16 v[56:59], v[116:119], v[88:91], v[56:59]
    ds_read_b64_tr_b16 v[116:117], v128 offset:12288
    ds_read_b64_tr_b16 v[118:119], v128 offset:12800
    s_waitcnt lgkmcnt(10)
    v_mfma_f32_16x16x32_bf16 v[60:63], v[120:123], v[76:79], v[60:63]
    v_mfma_f32_16x16x32_bf16 v[64:67], v[120:123], v[80:83], v[64:67]
    v_mfma_f32_16x16x32_bf16 v[68:71], v[120:123], v[84:87], v[68:71]
    v_mfma_f32_16x16x32_bf16 v[72:75], v[120:123], v[88:91], v[72:75]
    ds_read_b64_tr_b16 v[120:121], v129 offset:12288
    ds_read_b64_tr_b16 v[122:123], v129 offset:12800
    s_waitcnt lgkmcnt(6)
    v_mfma_f32_16x16x32_bf16 v[12:15], v[108:111], v[92:95], v[12:15]
    v_mfma_f32_16x16x32_bf16 v[16:19], v[108:111], v[96:99], v[16:19]
    v_mfma_f32_16x16x32_bf16 v[20:23], v[108:111], v[100:103], v[20:23]
    v_mfma_f32_16x16x32_bf16 v[24:27], v[108:111], v[104:107], v[24:27]
    s_waitcnt lgkmcnt(0)
    s_barrier
    v_mfma_f32_16x16x32_bf16 v[28:31], v[112:115], v[92:95], v[28:31]
    ds_read_b64_tr_b16 v[108:109], v126 offset:16384
    ds_read_b64_tr_b16 v[110:111], v126 offset:16896
    s_waitcnt vmcnt(0)
    v_mov_b32 v152, -1
    v_mfma_f32_16x16x32_bf16 v[32:35], v[112:115], v[96:99], v[32:35]
    ds_read_b128 v[76:79], v124 offset:32768
    ds_read_b128 v[80:83], v124 offset:34816
    v_mov_b32 v153, -1
    v_mov_b32 v154, -1
    v_mfma_f32_16x16x32_bf16 v[36:39], v[112:115], v[100:103], v[36:39]
    ds_read_b128 v[84:87], v124 offset:36864
    ds_read_b128 v[88:91], v124 offset:38912
    v_mov_b32 v155, -1
    v_lshlrev_b32 v164, 4, v1
    v_mfma_f32_16x16x32_bf16 v[40:43], v[112:115], v[104:107], v[40:43]
    ds_read_b64_tr_b16 v[112:113], v127 offset:16384
    ds_read_b64_tr_b16 v[114:115], v127 offset:16896
    v_lshlrev_b32 v165, 2, v1
    buffer_store_dwordx4 v[152:155], v164, s[20:23], s36 offen sc1
    v_mfma_f32_16x16x32_bf16 v[44:47], v[116:119], v[92:95], v[44:47]
    buffer_store_dword v152, v165, s[20:23], s37 offen sc1
    v_lshlrev_b32 v152, 16, v132
    v_and_b32 v153, 0xffff0000, v132
    v_mfma_f32_16x16x32_bf16 v[48:51], v[116:119], v[96:99], v[48:51]
    v_lshlrev_b32 v154, 16, v133
    v_and_b32 v155, 0xffff0000, v133
    v_mfma_f32_16x16x32_bf16 v[52:55], v[116:119], v[100:103], v[52:55]
    v_lshlrev_b32 v156, 16, v134
    v_and_b32 v157, 0xffff0000, v134
    v_mfma_f32_16x16x32_bf16 v[56:59], v[116:119], v[104:107], v[56:59]
    ds_read_b64_tr_b16 v[116:117], v128 offset:16384
    ds_read_b64_tr_b16 v[118:119], v128 offset:16896
    v_lshlrev_b32 v158, 16, v135
    v_and_b32 v159, 0xffff0000, v135
    v_mfma_f32_16x16x32_bf16 v[60:63], v[120:123], v[92:95], v[60:63]
    v_lshlrev_b32 v164, 16, v136
    v_and_b32 v165, 0xffff0000, v136
    v_mfma_f32_16x16x32_bf16 v[64:67], v[120:123], v[96:99], v[64:67]
    v_add_f32 v152, v152, v164
    v_add_f32 v153, v153, v165
    v_lshlrev_b32 v162, 16, v137
    v_mfma_f32_16x16x32_bf16 v[68:71], v[120:123], v[100:103], v[68:71]
    v_and_b32 v163, 0xffff0000, v137
    v_add_f32 v154, v154, v162
    v_mfma_f32_16x16x32_bf16 v[72:75], v[120:123], v[104:107], v[72:75]
    ds_read_b64_tr_b16 v[120:121], v129 offset:16384
    ds_read_b64_tr_b16 v[122:123], v129 offset:16896
    v_add_f32 v155, v155, v163
    v_lshlrev_b32 v164, 16, v138
    s_waitcnt lgkmcnt(6)
    v_mfma_f32_16x16x32_bf16 v[12:15], v[108:111], v[76:79], v[12:15]
    v_and_b32 v165, 0xffff0000, v138
    v_add_f32 v156, v156, v164
    v_mfma_f32_16x16x32_bf16 v[16:19], v[108:111], v[80:83], v[16:19]
    v_add_f32 v157, v157, v165
    v_lshlrev_b32 v162, 16, v139
    v_and_b32 v163, 0xffff0000, v139
    v_mfma_f32_16x16x32_bf16 v[20:23], v[108:111], v[84:87], v[20:23]
    v_add_f32 v158, v158, v162
    v_add_f32 v159, v159, v163
    v_mfma_f32_16x16x32_bf16 v[24:27], v[108:111], v[88:91], v[24:27]
    v_lshlrev_b32 v164, 16, v140
    v_and_b32 v165, 0xffff0000, v140
    s_waitcnt lgkmcnt(4)
    v_mfma_f32_16x16x32_bf16 v[28:31], v[112:115], v[76:79], v[28:31]
    ds_read_b64_tr_b16 v[108:109], v126 offset:20480
    ds_read_b64_tr_b16 v[110:111], v126 offset:20992
    v_add_f32 v152, v152, v164
    v_add_f32 v153, v153, v165
    v_mfma_f32_16x16x32_bf16 v[32:35], v[112:115], v[80:83], v[32:35]
    ds_read_b128 v[92:95], v125 offset:32768
    ds_read_b128 v[96:99], v125 offset:34816
    v_lshlrev_b32 v162, 16, v141
    v_and_b32 v163, 0xffff0000, v141
    v_mfma_f32_16x16x32_bf16 v[36:39], v[112:115], v[84:87], v[36:39]
    ds_read_b128 v[100:103], v125 offset:36864
    ds_read_b128 v[104:107], v125 offset:38912
    v_add_f32 v154, v154, v162
    v_add_f32 v155, v155, v163
    v_lshlrev_b32 v164, 16, v142
    v_mfma_f32_16x16x32_bf16 v[40:43], v[112:115], v[88:91], v[40:43]
    ds_read_b64_tr_b16 v[112:113], v127 offset:20480
    ds_read_b64_tr_b16 v[114:115], v127 offset:20992
    v_and_b32 v165, 0xffff0000, v142
    v_add_f32 v156, v156, v164
    s_waitcnt lgkmcnt(10)
    v_mfma_f32_16x16x32_bf16 v[44:47], v[116:119], v[76:79], v[44:47]
    v_add_f32 v157, v157, v165
    v_lshlrev_b32 v162, 16, v143
    v_mfma_f32_16x16x32_bf16 v[48:51], v[116:119], v[80:83], v[48:51]
    v_and_b32 v163, 0xffff0000, v143
    v_add_f32 v158, v158, v162
    v_mfma_f32_16x16x32_bf16 v[52:55], v[116:119], v[84:87], v[52:55]
    v_add_f32 v159, v159, v163
    v_lshlrev_b32 v164, 16, v144
    v_and_b32 v165, 0xffff0000, v144
    v_mfma_f32_16x16x32_bf16 v[56:59], v[116:119], v[88:91], v[56:59]
    ds_read_b64_tr_b16 v[116:117], v128 offset:20480
    ds_read_b64_tr_b16 v[118:119], v128 offset:20992
    v_add_f32 v152, v152, v164
    v_add_f32 v153, v153, v165
    s_waitcnt lgkmcnt(10)
    v_mfma_f32_16x16x32_bf16 v[60:63], v[120:123], v[76:79], v[60:63]
    v_lshlrev_b32 v162, 16, v145
    v_and_b32 v163, 0xffff0000, v145
    v_mfma_f32_16x16x32_bf16 v[64:67], v[120:123], v[80:83], v[64:67]
    v_add_f32 v154, v154, v162
    v_add_f32 v155, v155, v163
    v_mfma_f32_16x16x32_bf16 v[68:71], v[120:123], v[84:87], v[68:71]
    v_lshlrev_b32 v164, 16, v146
    v_and_b32 v165, 0xffff0000, v146
    v_mfma_f32_16x16x32_bf16 v[72:75], v[120:123], v[88:91], v[72:75]
    ds_read_b64_tr_b16 v[120:121], v129 offset:20480
    ds_read_b64_tr_b16 v[122:123], v129 offset:20992
    v_add_f32 v156, v156, v164
    v_add_f32 v157, v157, v165
    v_lshlrev_b32 v162, 16, v147
    s_waitcnt lgkmcnt(6)
    v_mfma_f32_16x16x32_bf16 v[12:15], v[108:111], v[92:95], v[12:15]
    v_and_b32 v163, 0xffff0000, v147
    v_add_f32 v158, v158, v162
    v_mfma_f32_16x16x32_bf16 v[16:19], v[108:111], v[96:99], v[16:19]
    v_add_f32 v159, v159, v163
    v_lshlrev_b32 v164, 16, v148
    v_mfma_f32_16x16x32_bf16 v[20:23], v[108:111], v[100:103], v[20:23]
    v_and_b32 v165, 0xffff0000, v148
    v_add_f32 v152, v152, v164
    v_mfma_f32_16x16x32_bf16 v[24:27], v[108:111], v[104:107], v[24:27]
    v_add_f32 v153, v153, v165
    v_lshlrev_b32 v162, 16, v149
    v_and_b32 v163, 0xffff0000, v149
    s_waitcnt lgkmcnt(0)
    s_barrier
    v_mfma_f32_16x16x32_bf16 v[28:31], v[112:115], v[92:95], v[28:31]
    ds_read_b64_tr_b16 v[108:109], v126 offset:0
    ds_read_b64_tr_b16 v[110:111], v126 offset:512
    v_add_f32 v154, v154, v162
    v_add_f32 v155, v155, v163
    v_mfma_f32_16x16x32_bf16 v[32:35], v[112:115], v[96:99], v[32:35]
    ds_read_b128 v[76:79], v124 offset:0
    ds_read_b128 v[80:83], v124 offset:2048
    v_lshlrev_b32 v164, 16, v150
    v_and_b32 v165, 0xffff0000, v150
    v_mfma_f32_16x16x32_bf16 v[36:39], v[112:115], v[100:103], v[36:39]
    ds_read_b128 v[84:87], v124 offset:4096
    ds_read_b128 v[88:91], v124 offset:6144
    v_add_f32 v156, v156, v164
    v_add_f32 v157, v157, v165
    v_mfma_f32_16x16x32_bf16 v[40:43], v[112:115], v[104:107], v[40:43]
    ds_read_b64_tr_b16 v[112:113], v127 offset:0
    ds_read_b64_tr_b16 v[114:115], v127 offset:512
    v_lshlrev_b32 v162, 16, v151
    v_and_b32 v163, 0xffff0000, v151
    v_mfma_f32_16x16x32_bf16 v[44:47], v[116:119], v[92:95], v[44:47]
    v_add_f32 v158, v158, v162
    v_add_f32 v159, v159, v163
    v_mfma_f32_16x16x32_bf16 v[48:51], v[116:119], v[96:99], v[48:51]
    s_nop 1
    v_permlane32_swap_b32 v152, v156
    v_permlane32_swap_b32 v153, v157
    v_mfma_f32_16x16x32_bf16 v[52:55], v[116:119], v[100:103], v[52:55]
    v_permlane32_swap_b32 v154, v158
    v_permlane32_swap_b32 v155, v159
    v_mfma_f32_16x16x32_bf16 v[56:59], v[116:119], v[104:107], v[56:59]
    ds_read_b64_tr_b16 v[116:117], v128 offset:0
    ds_read_b64_tr_b16 v[118:119], v128 offset:512
    s_nop 1
    v_add_f32 v152, v152, v156
    v_mfma_f32_16x16x32_bf16 v[60:63], v[120:123], v[92:95], v[60:63]
    v_add_f32 v153, v153, v157
    v_add_f32 v154, v154, v158
    v_mfma_f32_16x16x32_bf16 v[64:67], v[120:123], v[96:99], v[64:67]
    v_add_f32 v155, v155, v159
    s_nop 1
    v_mfma_f32_16x16x32_bf16 v[68:71], v[120:123], v[100:103], v[68:71]
    v_permlane16_swap_b32 v152, v154
    v_permlane16_swap_b32 v153, v155
    s_nop 1
    v_mfma_f32_16x16x32_bf16 v[72:75], v[120:123], v[104:107], v[72:75]
    ds_read_b64_tr_b16 v[120:121], v129 offset:0
    ds_read_b64_tr_b16 v[122:123], v129 offset:512
    v_add_f32 v152, v152, v154
    v_add_f32 v153, v153, v155
    s_waitcnt lgkmcnt(6)
    v_mfma_f32_16x16x32_bf16 v[12:15], v[108:111], v[76:79], v[12:15]
    s_nop 1
    v_add_f32_dpp v152, v152, v152 row_ror:8 row_mask:0xf bank_mask:0xf
    v_mfma_f32_16x16x32_bf16 v[16:19], v[108:111], v[80:83], v[16:19]
    v_add_f32_dpp v153, v153, v153 row_ror:8 row_mask:0xf bank_mask:0xf
    s_mov_b32 vcc_lo, 0xff00ff00
    v_mfma_f32_16x16x32_bf16 v[20:23], v[108:111], v[84:87], v[20:23]
    s_mov_b32 vcc_hi, 0xff00ff00
    v_cndmask_b32 v160, v152, v153, vcc
    v_mfma_f32_16x16x32_bf16 v[24:27], v[108:111], v[88:91], v[24:27]
    v_cvt_pk_bf16_f32 v161, v160, v160
    v_and_b32 v161, 0xffff0000, v161
    v_sub_f32 v161, v160, v161
    s_waitcnt lgkmcnt(4)
    v_mfma_f32_16x16x32_bf16 v[28:31], v[112:115], v[76:79], v[28:31]
    ds_read_b64_tr_b16 v[108:109], v126 offset:4096
    ds_read_b64_tr_b16 v[110:111], v126 offset:4608
    v_cvt_pk_bf16_f32 v160, v160, v161
    v_and_b32 v161, 7, v1
    v_mfma_f32_16x16x32_bf16 v[32:35], v[112:115], v[80:83], v[32:35]
    ds_read_b128 v[92:95], v125 offset:0
    ds_read_b128 v[96:99], v125 offset:2048
    v_lshl_add_u32 v161, v161, 1, v2
    v_bfe_u32 v162, v1, 4, 1
    v_mfma_f32_16x16x32_bf16 v[36:39], v[112:115], v[84:87], v[36:39]
    ds_read_b128 v[100:103], v125 offset:4096
    ds_read_b128 v[104:107], v125 offset:6144
    v_lshl_add_u32 v161, v161, 1, v162
    v_bfe_u32 v162, v1, 3, 1
    v_mfma_f32_16x16x32_bf16 v[40:43], v[112:115], v[88:91], v[40:43]
    ds_read_b64_tr_b16 v[112:113], v127 offset:4096
    ds_read_b64_tr_b16 v[114:115], v127 offset:4608
    v_lshl_add_u32 v161, v161, 1, v162
    v_and_b32 v162, 15, v161
    s_waitcnt lgkmcnt(10)
    v_mfma_f32_16x16x32_bf16 v[44:47], v[116:119], v[76:79], v[44:47]
    v_lshrrev_b32 v163, 4, v161
    s_and_b32 s44, s26, 1
    v_mfma_f32_16x16x32_bf16 v[48:51], v[116:119], v[80:83], v[48:51]
    s_andn2_b32 s44, s44, s48
    s_lshl_b32 s44, s44, 7
    s_lshr_b32 s45, s26, 1
    v_mfma_f32_16x16x32_bf16 v[52:55], v[116:119], v[84:87], v[52:55]
    s_lshl_b32 s45, s45, 4
    s_add_u32 s44, s44, s45
    v_mfma_f32_16x16x32_bf16 v[56:59], v[116:119], v[88:91], v[56:59]
    ds_read_b64_tr_b16 v[116:117], v128 offset:4096
    ds_read_b64_tr_b16 v[118:119], v128 offset:4608
    v_lshl_add_u32 v164, v163, 5, s44
    s_add_u32 s44, s26, 3
    s_waitcnt lgkmcnt(10)
    v_mfma_f32_16x16x32_bf16 v[60:63], v[120:123], v[76:79], v[60:63]
    s_lshl_b32 s44, s44, 5
    v_lshl_add_u32 v165, v163, 4, s44
    v_mfma_f32_16x16x32_bf16 v[64:67], v[120:123], v[80:83], v[64:67]
    s_cmp_eq_u32 s51, 1
    s_cselect_b64 vcc, -1, 0
    v_mfma_f32_16x16x32_bf16 v[68:71], v[120:123], v[84:87], v[68:71]
    v_cndmask_b32 v164, v164, v165, vcc
    v_add_lshl_u32 v162, v162, v164, 2
    s_lshl_b32 s44, s28, 14
    v_mfma_f32_16x16x32_bf16 v[72:75], v[120:123], v[88:91], v[72:75]
    ds_read_b64_tr_b16 v[120:121], v129 offset:4096
    ds_read_b64_tr_b16 v[122:123], v129 offset:4608
    s_lshl_b32 s45, s27, 10
    s_add_u32 s44, s44, s45
    s_waitcnt lgkmcnt(6)
    v_mfma_f32_16x16x32_bf16 v[12:15], v[108:111], v[92:95], v[12:15]
    s_add_u32 s44, s44, 14811136
    buffer_store_dword v160, v162, s[20:23], s44 offen sc1
    v_mfma_f32_16x16x32_bf16 v[16:19], v[108:111], v[96:99], v[16:19]
    s_lshl_b32 s46, s27, 2
    s_add_u32 s46, s46, s26
    v_mfma_f32_16x16x32_bf16 v[20:23], v[108:111], v[100:103], v[20:23]
    s_lshl_b32 s46, s46, 7
    s_lshl_b32 s45, s28, 13
    v_mfma_f32_16x16x32_bf16 v[24:27], v[108:111], v[104:107], v[24:27]
    s_add_u32 s46, s46, s45
    s_add_u32 s56, s46, 19005440
    buffer_load_dword v130, off, s[4:7], 0 sc1
    s_branch join_9
rowv_8:
    s_waitcnt vmcnt(4)
    s_barrier
    ds_read_b64_tr_b16 v[108:109], v126 offset:0
    ds_read_b64_tr_b16 v[110:111], v126 offset:512
    ds_read_b128 v[76:79], v124 offset:0
    ds_read_b128 v[80:83], v124 offset:2048
    ds_read_b128 v[84:87], v124 offset:4096
    ds_read_b128 v[88:91], v124 offset:6144
    ds_read_b64_tr_b16 v[112:113], v127 offset:0
    ds_read_b64_tr_b16 v[114:115], v127 offset:512
    ds_read_b64_tr_b16 v[116:117], v128 offset:0
    ds_read_b64_tr_b16 v[118:119], v128 offset:512
    ds_read_b64_tr_b16 v[120:121], v129 offset:0
    ds_read_b64_tr_b16 v[122:123], v129 offset:512
    s_waitcnt lgkmcnt(6)
    v_mfma_f32_16x16x32_bf16 v[12:15], v[108:111], v[76:79], 0
    v_mfma_f32_16x16x32_bf16 v[16:19], v[108:111], v[80:83], 0
    s_lshl_b32 s44, s27, 7
    v_mfma_f32_16x16x32_bf16 v[20:23], v[108:111], v[84:87], 0
    v_mfma_f32_16x16x32_bf16 v[24:27], v[108:111], v[88:91], 0
    s_lshl_b32 s45, s28, 3
    s_waitcnt lgkmcnt(4)
    v_mfma_f32_16x16x32_bf16 v[28:31], v[112:115], v[76:79], 0
    ds_read_b64_tr_b16 v[108:109], v126 offset:4096
    ds_read_b64_tr_b16 v[110:111], v126 offset:4608
    s_add_u32 s44, s44, s45
    v_mfma_f32_16x16x32_bf16 v[32:35], v[112:115], v[80:83], 0
    ds_read_b128 v[92:95], v125 offset:0
    ds_read_b128 v[96:99], v125 offset:2048
    v_mfma_f32_16x16x32_bf16 v[36:39], v[112:115], v[84:87], 0
    ds_read_b128 v[100:103], v125 offset:4096
    ds_read_b128 v[104:107], v125 offset:6144
    s_lshl_b32 s45, s26, 1
    v_mfma_f32_16x16x32_bf16 v[40:43], v[112:115], v[88:91], 0
    ds_read_b64_tr_b16 v[112:113], v127 offset:4096
    ds_read_b64_tr_b16 v[114:115], v127 offset:4608
    s_add_u32 s55, s44, s45
    s_waitcnt lgkmcnt(10)
    v_mfma_f32_16x16x32_bf16 v[44:47], v[116:119], v[76:79], 0
    v_mfma_f32_16x16x32_bf16 v[48:51], v[116:119], v[80:83], 0
    v_add_u32 v160, s55, v2
    v_mfma_f32_16x16x32_bf16 v[52:55], v[116:119], v[84:87], 0
    v_mul_u32_u24 v160, 1280, v160
    v_mfma_f32_16x16x32_bf16 v[56:59], v[116:119], v[88:91], 0
    ds_read_b64_tr_b16 v[116:117], v128 offset:4096
    ds_read_b64_tr_b16 v[118:119], v128 offset:4608
    s_waitcnt lgkmcnt(10)
    v_mfma_f32_16x16x32_bf16 v[60:63], v[120:123], v[76:79], 0
    v_lshl_add_u32 v160, v3, 3, v160
    v_mfma_f32_16x16x32_bf16 v[64:67], v[120:123], v[80:83], 0
    buffer_load_dwordx2 v[132:133], v160, s[8:11], 0 offen offset:0
    v_mfma_f32_16x16x32_bf16 v[68:71], v[120:123], v[84:87], 0
    v_mfma_f32_16x16x32_bf16 v[72:75], v[120:123], v[88:91], 0
    ds_read_b64_tr_b16 v[120:121], v129 offset:4096
    ds_read_b64_tr_b16 v[122:123], v129 offset:4608
    buffer_load_dwordx2 v[134:135], v160, s[8:11], 0 offen offset:256
    s_waitcnt lgkmcnt(6)
    v_mfma_f32_16x16x32_bf16 v[12:15], v[108:111], v[92:95], v[12:15]
    buffer_load_dwordx2 v[136:137], v160, s[8:11], 0 offen offset:512
    v_mfma_f32_16x16x32_bf16 v[16:19], v[108:111], v[96:99], v[16:19]
    v_mfma_f32_16x16x32_bf16 v[20:23], v[108:111], v[100:103], v[20:23]
    buffer_load_dwordx2 v[138:139], v160, s[8:11], 0 offen offset:768
    v_mfma_f32_16x16x32_bf16 v[24:27], v[108:111], v[104:107], v[24:27]
    buffer_load_dwordx2 v[140:141], v160, s[8:11], 0 offen offset:1024
    s_waitcnt vmcnt(5)
    s_waitcnt lgkmcnt(0)
    s_barrier
    v_mfma_f32_16x16x32_bf16 v[28:31], v[112:115], v[92:95], v[28:31]
    ds_read_b64_tr_b16 v[108:109], v126 offset:8192
    ds_read_b64_tr_b16 v[110:111], v126 offset:8704
    v_mfma_f32_16x16x32_bf16 v[32:35], v[112:115], v[96:99], v[32:35]
    ds_read_b128 v[76:79], v124 offset:16384
    ds_read_b128 v[80:83], v124 offset:18432
    v_mfma_f32_16x16x32_bf16 v[36:39], v[112:115], v[100:103], v[36:39]
    ds_read_b128 v[84:87], v124 offset:20480
    ds_read_b128 v[88:91], v124 offset:22528
    v_mfma_f32_16x16x32_bf16 v[40:43], v[112:115], v[104:107], v[40:43]
    ds_read_b64_tr_b16 v[112:113], v127 offset:8192
    ds_read_b64_tr_b16 v[114:115], v127 offset:8704
    v_mfma_f32_16x16x32_bf16 v[44:47], v[116:119], v[92:95], v[44:47]
    v_mfma_f32_16x16x32_bf16 v[48:51], v[116:119], v[96:99], v[48:51]
    v_mfma_f32_16x16x32_bf16 v[52:55], v[116:119], v[100:103], v[52:55]
    v_mfma_f32_16x16x32_bf16 v[56:59], v[116:119], v[104:107], v[56:59]
    ds_read_b64_tr_b16 v[116:117], v128 offset:8192
    ds_read_b64_tr_b16 v[118:119], v128 offset:8704
    v_mfma_f32_16x16x32_bf16 v[60:63], v[120:123], v[92:95], v[60:63]
    v_mfma_f32_16x16x32_bf16 v[64:67], v[120:123], v[96:99], v[64:67]
    v_mfma_f32_16x16x32_bf16 v[68:71], v[120:123], v[100:103], v[68:71]
    v_mfma_f32_16x16x32_bf16 v[72:75], v[120:123], v[104:107], v[72:75]
    ds_read_b64_tr_b16 v[120:121], v129 offset:8192
    ds_read_b64_tr_b16 v[122:123], v129 offset:8704
    s_waitcnt lgkmcnt(6)
    v_mfma_f32_16x16x32_bf16 v[12:15], v[108:111], v[76:79], v[12:15]
    v_mfma_f32_16x16x32_bf16 v[16:19], v[108:111], v[80:83], v[16:19]
    v_mfma_f32_16x16x32_bf16 v[20:23], v[108:111], v[84:87], v[20:23]
    v_mfma_f32_16x16x32_bf16 v[24:27], v[108:111], v[88:91], v[24:27]
    s_waitcnt lgkmcnt(4)
    v_mfma_f32_16x16x32_bf16 v[28:31], v[112:115], v[76:79], v[28:31]
    ds_read_b64_tr_b16 v[108:109], v126 offset:12288
    ds_read_b64_tr_b16 v[110:111], v126 offset:12800
    v_mfma_f32_16x16x32_bf16 v[32:35], v[112:115], v[80:83], v[32:35]
    ds_read_b128 v[92:95], v125 offset:16384
    ds_read_b128 v[96:99], v125 offset:18432
    v_mfma_f32_16x16x32_bf16 v[36:39], v[112:115], v[84:87], v[36:39]
    ds_read_b128 v[100:103], v125 offset:20480
    ds_read_b128 v[104:107], v125 offset:22528
    v_mfma_f32_16x16x32_bf16 v[40:43], v[112:115], v[88:91], v[40:43]
    ds_read_b64_tr_b16 v[112:113], v127 offset:12288
    ds_read_b64_tr_b16 v[114:115], v127 offset:12800
    s_waitcnt lgkmcnt(10)
    v_mfma_f32_16x16x32_bf16 v[44:47], v[116:119], v[76:79], v[44:47]
    v_mfma_f32_16x16x32_bf16 v[48:51], v[116:119], v[80:83], v[48:51]
    v_mfma_f32_16x16x32_bf16 v[52:55], v[116:119], v[84:87], v[52:55]
    v_mfma_f32_16x16x32_bf16 v[56:59], v[116:119], v[88:91], v[56:59]
    ds_read_b64_tr_b16 v[116:117], v128 offset:12288
    ds_read_b64_tr_b16 v[118:119], v128 offset:12800
    s_waitcnt lgkmcnt(10)
    v_mfma_f32_16x16x32_bf16 v[60:63], v[120:123], v[76:79], v[60:63]
    v_mfma_f32_16x16x32_bf16 v[64:67], v[120:123], v[80:83], v[64:67]
    v_mfma_f32_16x16x32_bf16 v[68:71], v[120:123], v[84:87], v[68:71]
    v_mfma_f32_16x16x32_bf16 v[72:75], v[120:123], v[88:91], v[72:75]
    ds_read_b64_tr_b16 v[120:121], v129 offset:12288
    ds_read_b64_tr_b16 v[122:123], v129 offset:12800
    s_waitcnt lgkmcnt(6)
    v_mfma_f32_16x16x32_bf16 v[12:15], v[108:111], v[92:95], v[12:15]
    v_mfma_f32_16x16x32_bf16 v[16:19], v[108:111], v[96:99], v[16:19]
    v_mfma_f32_16x16x32_bf16 v[20:23], v[108:111], v[100:103], v[20:23]
    v_mfma_f32_16x16x32_bf16 v[24:27], v[108:111], v[104:107], v[24:27]
    s_waitcnt lgkmcnt(0)
    s_barrier
    v_mfma_f32_16x16x32_bf16 v[28:31], v[112:115], v[92:95], v[28:31]
    ds_read_b64_tr_b16 v[108:109], v126 offset:16384
    ds_read_b64_tr_b16 v[110:111], v126 offset:16896
    s_waitcnt vmcnt(0)
    v_mov_b32 v152, -1
    v_mfma_f32_16x16x32_bf16 v[32:35], v[112:115], v[96:99], v[32:35]
    ds_read_b128 v[76:79], v124 offset:32768
    ds_read_b128 v[80:83], v124 offset:34816
    v_mov_b32 v153, -1
    v_mov_b32 v154, -1
    v_mfma_f32_16x16x32_bf16 v[36:39], v[112:115], v[100:103], v[36:39]
    ds_read_b128 v[84:87], v124 offset:36864
    ds_read_b128 v[88:91], v124 offset:38912
    v_mov_b32 v155, -1
    v_lshlrev_b32 v164, 4, v1
    v_mfma_f32_16x16x32_bf16 v[40:43], v[112:115], v[104:107], v[40:43]
    ds_read_b64_tr_b16 v[112:113], v127 offset:16384
    ds_read_b64_tr_b16 v[114:115], v127 offset:16896
    v_lshlrev_b32 v165, 2, v1
    buffer_store_dwordx4 v[152:155], v164, s[20:23], s36 offen sc1
    v_mfma_f32_16x16x32_bf16 v[44:47], v[116:119], v[92:95], v[44:47]
    buffer_store_dword v152, v165, s[20:23], s37 offen sc1
    s_mul_i32 s44, s27, 163840
    v_mfma_f32_16x16x32_bf16 v[48:51], v[116:119], v[96:99], v[48:51]
    s_mul_i32 s45, s28, 10240
    s_add_u32 s44, s44, s45
    v_mfma_f32_16x16x32_bf16 v[52:55], v[116:119], v[100:103], v[52:55]
    s_mul_i32 s45, s26, 2560
    s_add_u32 s44, s44, s45
    v_mfma_f32_16x16x32_bf16 v[56:59], v[116:119], v[104:107], v[56:59]
    ds_read_b64_tr_b16 v[116:117], v128 offset:16384
    ds_read_b64_tr_b16 v[118:119], v128 offset:16896
    s_add_u32 s44, s44, 7340032
    v_lshlrev_b32 v165, 3, v1
    v_mfma_f32_16x16x32_bf16 v[60:63], v[120:123], v[92:95], v[60:63]
    buffer_store_dwordx4 v[152:155], v164, s[20:23], s44 offen sc1
    buffer_store_dwordx4 v[152:155], v164, s[20:23], s44 offen offset:1024 sc1
    v_mfma_f32_16x16x32_bf16 v[64:67], v[120:123], v[96:99], v[64:67]
    buffer_store_dwordx2 v[152:153], v165, s[20:23], s44 offen offset:2048 sc1
    v_mov_b32 v160, 0
    v_mfma_f32_16x16x32_bf16 v[68:71], v[120:123], v[100:103], v[68:71]
    v_mov_b32 v161, 0
    v_lshlrev_b32 v162, 16, v132
    v_mfma_f32_16x16x32_bf16 v[72:75], v[120:123], v[104:107], v[72:75]
    ds_read_b64_tr_b16 v[120:121], v129 offset:16384
    ds_read_b64_tr_b16 v[122:123], v129 offset:16896
    v_and_b32 v163, 0xffff0000, v132
    v_add_f32 v160, v160, v162
    s_waitcnt lgkmcnt(6)
    v_mfma_f32_16x16x32_bf16 v[12:15], v[108:111], v[76:79], v[12:15]
    v_fmac_f32 v161, v162, v162
    v_add_f32 v160, v160, v163
    v_mfma_f32_16x16x32_bf16 v[16:19], v[108:111], v[80:83], v[16:19]
    v_fmac_f32 v161, v163, v163
    v_lshlrev_b32 v162, 16, v133
    v_mfma_f32_16x16x32_bf16 v[20:23], v[108:111], v[84:87], v[20:23]
    v_and_b32 v163, 0xffff0000, v133
    v_add_f32 v160, v160, v162
    v_mfma_f32_16x16x32_bf16 v[24:27], v[108:111], v[88:91], v[24:27]
    v_fmac_f32 v161, v162, v162
    v_add_f32 v160, v160, v163
    s_waitcnt lgkmcnt(4)
    v_mfma_f32_16x16x32_bf16 v[28:31], v[112:115], v[76:79], v[28:31]
    ds_read_b64_tr_b16 v[108:109], v126 offset:20480
    ds_read_b64_tr_b16 v[110:111], v126 offset:20992
    v_fmac_f32 v161, v163, v163
    v_lshlrev_b32 v162, 16, v134
    v_mfma_f32_16x16x32_bf16 v[32:35], v[112:115], v[80:83], v[32:35]
    ds_read_b128 v[92:95], v125 offset:32768
    ds_read_b128 v[96:99], v125 offset:34816
    v_and_b32 v163, 0xffff0000, v134
    v_add_f32 v160, v160, v162
    v_mfma_f32_16x16x32_bf16 v[36:39], v[112:115], v[84:87], v[36:39]
    ds_read_b128 v[100:103], v125 offset:36864
    ds_read_b128 v[104:107], v125 offset:38912
    v_fmac_f32 v161, v162, v162
    v_add_f32 v160, v160, v163
    v_mfma_f32_16x16x32_bf16 v[40:43], v[112:115], v[88:91], v[40:43]
    ds_read_b64_tr_b16 v[112:113], v127 offset:20480
    ds_read_b64_tr_b16 v[114:115], v127 offset:20992
    v_fmac_f32 v161, v163, v163
    v_lshlrev_b32 v162, 16, v135
    s_waitcnt lgkmcnt(10)
    v_mfma_f32_16x16x32_bf16 v[44:47], v[116:119], v[76:79], v[44:47]
    v_and_b32 v163, 0xffff0000, v135
    v_add_f32 v160, v160, v162
    v_mfma_f32_16x16x32_bf16 v[48:51], v[116:119], v[80:83], v[48:51]
    v_fmac_f32 v161, v162, v162
    v_add_f32 v160, v160, v163
    v_mfma_f32_16x16x32_bf16 v[52:55], v[116:119], v[84:87], v[52:55]
    v_fmac_f32 v161, v163, v163
    v_lshlrev_b32 v162, 16, v136
    v_mfma_f32_16x16x32_bf16 v[56:59], v[116:119], v[88:91], v[56:59]
    ds_read_b64_tr_b16 v[116:117], v128 offset:20480
    ds_read_b64_tr_b16 v[118:119], v128 offset:20992
    v_and_b32 v163, 0xffff0000, v136
    v_add_f32 v160, v160, v162
    s_waitcnt lgkmcnt(10)
    v_mfma_f32_16x16x32_bf16 v[60:63], v[120:123], v[76:79], v[60:63]
    v_fmac_f32 v161, v162, v162
    v_add_f32 v160, v160, v163
    v_mfma_f32_16x16x32_bf16 v[64:67], v[120:123], v[80:83], v[64:67]
    v_fmac_f32 v161, v163, v163
    v_lshlrev_b32 v162, 16, v137
    v_mfma_f32_16x16x32_bf16 v[68:71], v[120:123], v[84:87], v[68:71]
    v_and_b32 v163, 0xffff0000, v137
    v_add_f32 v160, v160, v162
    v_mfma_f32_16x16x32_bf16 v[72:75], v[120:123], v[88:91], v[72:75]
    ds_read_b64_tr_b16 v[120:121], v129 offset:20480
    ds_read_b64_tr_b16 v[122:123], v129 offset:20992
    v_fmac_f32 v161, v162, v162
    v_add_f32 v160, v160, v163
    s_waitcnt lgkmcnt(6)
    v_mfma_f32_16x16x32_bf16 v[12:15], v[108:111], v[92:95], v[12:15]
    v_fmac_f32 v161, v163, v163
    v_lshlrev_b32 v162, 16, v138
    v_mfma_f32_16x16x32_bf16 v[16:19], v[108:111], v[96:99], v[16:19]
    v_and_b32 v163, 0xffff0000, v138
    v_add_f32 v160, v160, v162
    v_mfma_f32_16x16x32_bf16 v[20:23], v[108:111], v[100:103], v[20:23]
    v_fmac_f32 v161, v162, v162
    v_add_f32 v160, v160, v163
    v_mfma_f32_16x16x32_bf16 v[24:27], v[108:111], v[104:107], v[24:27]
    v_fmac_f32 v161, v163, v163
    v_lshlrev_b32 v162, 16, v139
    v_and_b32 v163, 0xffff0000, v139
    s_waitcnt lgkmcnt(0)
    s_barrier
    v_mfma_f32_16x16x32_bf16 v[28:31], v[112:115], v[92:95], v[28:31]
    ds_read_b64_tr_b16 v[108:109], v126 offset:0
    ds_read_b64_tr_b16 v[110:111], v126 offset:512
    v_add_f32 v160, v160, v162
    v_fmac_f32 v161, v162, v162
    v_mfma_f32_16x16x32_bf16 v[32:35], v[112:115], v[96:99], v[32:35]
    ds_read_b128 v[76:79], v124 offset:0
    ds_read_b128 v[80:83], v124 offset:2048
    v_add_f32 v160, v160, v163
    v_fmac_f32 v161, v163, v163
    v_mfma_f32_16x16x32_bf16 v[36:39], v[112:115], v[100:103], v[36:39]
    ds_read_b128 v[84:87], v124 offset:4096
    ds_read_b128 v[88:91], v124 offset:6144
    v_lshlrev_b32 v162, 16, v140
    v_and_b32 v163, 0xffff0000, v140
    v_mfma_f32_16x16x32_bf16 v[40:43], v[112:115], v[104:107], v[40:43]
    ds_read_b64_tr_b16 v[112:113], v127 offset:0
    ds_read_b64_tr_b16 v[114:115], v127 offset:512
    v_add_f32 v160, v160, v162
    v_fmac_f32 v161, v162, v162
    v_mfma_f32_16x16x32_bf16 v[44:47], v[116:119], v[92:95], v[44:47]
    v_add_f32 v160, v160, v163
    v_fmac_f32 v161, v163, v163
    v_mfma_f32_16x16x32_bf16 v[48:51], v[116:119], v[96:99], v[48:51]
    v_lshlrev_b32 v162, 16, v141
    v_and_b32 v163, 0xffff0000, v141
    v_mfma_f32_16x16x32_bf16 v[52:55], v[116:119], v[100:103], v[52:55]
    v_add_f32 v160, v160, v162
    v_fmac_f32 v161, v162, v162
    v_mfma_f32_16x16x32_bf16 v[56:59], v[116:119], v[104:107], v[56:59]
    ds_read_b64_tr_b16 v[116:117], v128 offset:0
    ds_read_b64_tr_b16 v[118:119], v128 offset:512
    v_add_f32 v160, v160, v163
    v_fmac_f32 v161, v163, v163
    v_mfma_f32_16x16x32_bf16 v[60:63], v[120:123], v[92:95], v[60:63]
    s_nop 1
    v_add_f32_dpp v160, v160, v160 row_ror:8 row_mask:0xf bank_mask:0xf
    v_mfma_f32_16x16x32_bf16 v[64:67], v[120:123], v[96:99], v[64:67]
    v_add_f32_dpp v161, v161, v161 row_ror:8 row_mask:0xf bank_mask:0xf
    s_nop 1
    v_mfma_f32_16x16x32_bf16 v[68:71], v[120:123], v[100:103], v[68:71]
    v_add_f32_dpp v160, v160, v160 row_ror:4 row_mask:0xf bank_mask:0xf
    v_add_f32_dpp v161, v161, v161 row_ror:4 row_mask:0xf bank_mask:0xf
    v_mfma_f32_16x16x32_bf16 v[72:75], v[120:123], v[104:107], v[72:75]
    ds_read_b64_tr_b16 v[120:121], v129 offset:0
    ds_read_b64_tr_b16 v[122:123], v129 offset:512
    s_nop 1
    v_add_f32_dpp v160, v160, v160 row_ror:2 row_mask:0xf bank_mask:0xf
    s_waitcnt lgkmcnt(6)
    v_mfma_f32_16x16x32_bf16 v[12:15], v[108:111], v[76:79], v[12:15]
    v_add_f32_dpp v161, v161, v161 row_ror:2 row_mask:0xf bank_mask:0xf
    s_nop 1
    v_mfma_f32_16x16x32_bf16 v[16:19], v[108:111], v[80:83], v[16:19]
    v_add_f32_dpp v160, v160, v160 row_ror:1 row_mask:0xf bank_mask:0xf
    v_add_f32_dpp v161, v161, v161 row_ror:1 row_mask:0xf bank_mask:0xf
    v_mfma_f32_16x16x32_bf16 v[20:23], v[108:111], v[84:87], v[20:23]
    v_mov_b32 v162, v160
    v_mov_b32 v163, v161
    v_mfma_f32_16x16x32_bf16 v[24:27], v[108:111], v[88:91], v[24:27]
    s_nop 1
    v_permlane16_swap_b32 v160, v162
    s_waitcnt lgkmcnt(4)
    v_mfma_f32_16x16x32_bf16 v[28:31], v[112:115], v[76:79], v[28:31]
    ds_read_b64_tr_b16 v[108:109], v126 offset:4096
    ds_read_b64_tr_b16 v[110:111], v126 offset:4608
    v_permlane16_swap_b32 v161, v163
    s_mov_b32 s44, 986500301
    v_mfma_f32_16x16x32_bf16 v[32:35], v[112:115], v[80:83], v[32:35]
    ds_read_b128 v[92:95], v125 offset:0
    ds_read_b128 v[96:99], v125 offset:2048
    s_mov_b32 s45, 925353388
    v_add_f32 v160, v160, v162
    v_mfma_f32_16x16x32_bf16 v[36:39], v[112:115], v[84:87], v[36:39]
    ds_read_b128 v[100:103], v125 offset:4096
    ds_read_b128 v[104:107], v125 offset:6144
    v_add_f32 v161, v161, v163
    v_mul_f32 v160, s44, v160
    v_mfma_f32_16x16x32_bf16 v[40:43], v[112:115], v[88:91], v[40:43]
    ds_read_b64_tr_b16 v[112:113], v127 offset:4096
    ds_read_b64_tr_b16 v[114:115], v127 offset:4608
    v_mul_f32 v161, s44, v161
    v_fma_f32 v161, -v160, v160, v161
    s_waitcnt lgkmcnt(10)
    v_mfma_f32_16x16x32_bf16 v[44:47], v[116:119], v[76:79], v[44:47]
    v_max_f32 v161, 0, v161
    v_cvt_pk_bf16_f32 v144, -v160, -v160
    v_mfma_f32_16x16x32_bf16 v[48:51], v[116:119], v[80:83], v[48:51]
    v_cvt_pk_bf16_f32 v161, v161, v161
    v_and_b32 v161, 0xffff0000, v161
    v_mfma_f32_16x16x32_bf16 v[52:55], v[116:119], v[84:87], v[52:55]
    v_add_f32 v161, s45, v161
    v_cvt_pk_bf16_f32 v161, v161, v161
    v_mfma_f32_16x16x32_bf16 v[56:59], v[116:119], v[88:91], v[56:59]
    ds_read_b64_tr_b16 v[116:117], v128 offset:4096
    ds_read_b64_tr_b16 v[118:119], v128 offset:4608
    v_and_b32 v161, 0xffff0000, v161
    v_sqrt_f32 v161, v161
    s_waitcnt lgkmcnt(10)
    v_mfma_f32_16x16x32_bf16 v[60:63], v[120:123], v[76:79], v[60:63]
    v_mov_b32 v147, 0
    v_cvt_pk_bf16_f32 v161, v161, v161
    v_mfma_f32_16x16x32_bf16 v[64:67], v[120:123], v[80:83], v[64:67]
    v_and_b32 v161, 0xffff0000, v161
    v_rcp_f32 v145, v161
    v_mfma_f32_16x16x32_bf16 v[68:71], v[120:123], v[84:87], v[68:71]
    v_mul_f32 v146, v161, v161
    v_lshlrev_b32 v162, 4, v2
    v_mfma_f32_16x16x32_bf16 v[72:75], v[120:123], v[88:91], v[72:75]
    ds_read_b64_tr_b16 v[120:121], v129 offset:4096
    ds_read_b64_tr_b16 v[122:123], v129 offset:4608
    s_lshl_b32 s44, s55, 4
    s_add_u32 s44, s44, 14745600
    s_waitcnt lgkmcnt(6)
    v_mfma_f32_16x16x32_bf16 v[12:15], v[108:111], v[92:95], v[12:15]
    s_mov_b32 exec_lo, 1
    s_mov_b32 exec_hi, 1
    buffer_store_dwordx4 v[144:147], v162, s[20:23], s44 offen sc1
    s_mov_b64 exec, -1
    s_lshl_b32 s44, s28, 2
    v_mfma_f32_16x16x32_bf16 v[16:19], v[108:111], v[96:99], v[16:19]
    s_add_u32 s44, s44, s26
    s_lshl_b32 s44, s44, 7
    v_mfma_f32_16x16x32_bf16 v[20:23], v[108:111], v[100:103], v[20:23]
    s_lshl_b32 s45, s27, 13
    s_add_u32 s44, s44, s45
    v_mfma_f32_16x16x32_bf16 v[24:27], v[108:111], v[104:107], v[24:27]
    s_add_u32 s56, s44, 18874368
    buffer_load_dword v130, off, s[4:7], 0 sc1
join_9:
    s_waitcnt lgkmcnt(0)
    s_barrier
    v_mfma_f32_16x16x32_bf16 v[28:31], v[112:115], v[92:95], v[28:31]
    ds_read_b64_tr_b16 v[108:109], v126 offset:8192
    ds_read_b64_tr_b16 v[110:111], v126 offset:8704
    v_mfma_f32_16x16x32_bf16 v[32:35], v[112:115], v[96:99], v[32:35]
    ds_read_b128 v[76:79], v124 offset:16384
    ds_read_b128 v[80:83], v124 offset:18432
    v_mfma_f32_16x16x32_bf16 v[36:39], v[112:115], v[100:103], v[36:39]
    ds_read_b128 v[84:87], v124 offset:20480
    ds_read_b128 v[88:91], v124 offset:22528
    v_mfma_f32_16x16x32_bf16 v[40:43], v[112:115], v[104:107], v[40:43]
    ds_read_b64_tr_b16 v[112:113], v127 offset:8192
    ds_read_b64_tr_b16 v[114:115], v127 offset:8704
    v_mfma_f32_16x16x32_bf16 v[44:47], v[116:119], v[92:95], v[44:47]
    v_mfma_f32_16x16x32_bf16 v[48:51], v[116:119], v[96:99], v[48:51]
    v_mfma_f32_16x16x32_bf16 v[52:55], v[116:119], v[100:103], v[52:55]
    v_mfma_f32_16x16x32_bf16 v[56:59], v[116:119], v[104:107], v[56:59]
    ds_read_b64_tr_b16 v[116:117], v128 offset:8192
    ds_read_b64_tr_b16 v[118:119], v128 offset:8704
    v_mfma_f32_16x16x32_bf16 v[60:63], v[120:123], v[92:95], v[60:63]
    v_mfma_f32_16x16x32_bf16 v[64:67], v[120:123], v[96:99], v[64:67]
    v_mfma_f32_16x16x32_bf16 v[68:71], v[120:123], v[100:103], v[68:71]
    v_mfma_f32_16x16x32_bf16 v[72:75], v[120:123], v[104:107], v[72:75]
    ds_read_b64_tr_b16 v[120:121], v129 offset:8192
    ds_read_b64_tr_b16 v[122:123], v129 offset:8704
    s_waitcnt lgkmcnt(6)
    v_mfma_f32_16x16x32_bf16 v[12:15], v[108:111], v[76:79], v[12:15]
    v_mfma_f32_16x16x32_bf16 v[16:19], v[108:111], v[80:83], v[16:19]
    v_mfma_f32_16x16x32_bf16 v[20:23], v[108:111], v[84:87], v[20:23]
    v_mfma_f32_16x16x32_bf16 v[24:27], v[108:111], v[88:91], v[24:27]
    s_waitcnt lgkmcnt(4)
    v_mfma_f32_16x16x32_bf16 v[28:31], v[112:115], v[76:79], v[28:31]
    ds_read_b64_tr_b16 v[108:109], v126 offset:12288
    ds_read_b64_tr_b16 v[110:111], v126 offset:12800
    v_mfma_f32_16x16x32_bf16 v[32:35], v[112:115], v[80:83], v[32:35]
    ds_read_b128 v[92:95], v125 offset:16384
    ds_read_b128 v[96:99], v125 offset:18432
    v_mfma_f32_16x16x32_bf16 v[36:39], v[112:115], v[84:87], v[36:39]
    ds_read_b128 v[100:103], v125 offset:20480
    ds_read_b128 v[104:107], v125 offset:22528
    v_mfma_f32_16x16x32_bf16 v[40:43], v[112:115], v[88:91], v[40:43]
    ds_read_b64_tr_b16 v[112:113], v127 offset:12288
    ds_read_b64_tr_b16 v[114:115], v127 offset:12800
    s_waitcnt lgkmcnt(10)
    v_mfma_f32_16x16x32_bf16 v[44:47], v[116:119], v[76:79], v[44:47]
    v_mfma_f32_16x16x32_bf16 v[48:51], v[116:119], v[80:83], v[48:51]
    v_mfma_f32_16x16x32_bf16 v[52:55], v[116:119], v[84:87], v[52:55]
    v_mfma_f32_16x16x32_bf16 v[56:59], v[116:119], v[88:91], v[56:59]
    ds_read_b64_tr_b16 v[116:117], v128 offset:12288
    ds_read_b64_tr_b16 v[118:119], v128 offset:12800
    s_waitcnt lgkmcnt(10)
    v_mfma_f32_16x16x32_bf16 v[60:63], v[120:123], v[76:79], v[60:63]
    v_mfma_f32_16x16x32_bf16 v[64:67], v[120:123], v[80:83], v[64:67]
    v_mfma_f32_16x16x32_bf16 v[68:71], v[120:123], v[84:87], v[68:71]
    v_mfma_f32_16x16x32_bf16 v[72:75], v[120:123], v[88:91], v[72:75]
    ds_read_b64_tr_b16 v[120:121], v129 offset:12288
    ds_read_b64_tr_b16 v[122:123], v129 offset:12800
    s_waitcnt lgkmcnt(6)
    v_mfma_f32_16x16x32_bf16 v[12:15], v[108:111], v[92:95], v[12:15]
    v_mfma_f32_16x16x32_bf16 v[16:19], v[108:111], v[96:99], v[16:19]
    v_mfma_f32_16x16x32_bf16 v[20:23], v[108:111], v[100:103], v[20:23]
    v_mfma_f32_16x16x32_bf16 v[24:27], v[108:111], v[104:107], v[24:27]
    s_mov_b32 s93, 400000
cnp_10:
    s_waitcnt vmcnt(0)
    v_readfirstlane_b32 s98, v130
    s_cmp_lg_u32 s98, 0
    s_cbranch_scc1 cnd_11
    s_sub_u32 s93, s93, 1
    s_cbranch_scc1 cnd_11
    buffer_load_dword v130, off, s[4:7], 0 sc1
    s_branch cnp_10
cnd_11:
    s_xor_b32 s99, s98, 1515870810
    s_cmp_lg_u32 s24, 0
    s_cbranch_scc1 noxid_12
    s_getreg_b32 s44, hwreg(HW_REG_XCC_ID, 0, 4)
    s_lshl_b32 s45, s29, 7
    s_lshl_b32 s46, s30, 3
    s_add_u32 s45, s45, s46
    s_add_u32 s45, s45, 19234816
    v_mov_b32 v160, s98
    v_mov_b32 v161, s44
    s_mov_b64 exec, 1
    buffer_store_dwordx2 v[160:161], off, s[20:23], s45 sc1
    s_mov_b64 exec, -1
noxid_12:
    v_mov_b32 v162, s98
    v_mov_b32 v163, s99
    s_mov_b64 exec, 1
    buffer_store_dwordx2 v[162:163], off, s[20:23], s56 sc1
    s_mov_b64 exec, -1
    s_waitcnt lgkmcnt(0)
    s_barrier
    v_mfma_f32_16x16x32_bf16 v[28:31], v[112:115], v[92:95], v[28:31]
    ds_read_b64_tr_b16 v[108:109], v126 offset:16384
    ds_read_b64_tr_b16 v[110:111], v126 offset:16896
    v_mfma_f32_16x16x32_bf16 v[32:35], v[112:115], v[96:99], v[32:35]
    ds_read_b128 v[76:79], v124 offset:32768
    ds_read_b128 v[80:83], v124 offset:34816
    v_mfma_f32_16x16x32_bf16 v[36:39], v[112:115], v[100:103], v[36:39]
    ds_read_b128 v[84:87], v124 offset:36864
    ds_read_b128 v[88:91], v124 offset:38912
    v_mfma_f32_16x16x32_bf16 v[40:43], v[112:115], v[104:107], v[40:43]
    ds_read_b64_tr_b16 v[112:113], v127 offset:16384
    ds_read_b64_tr_b16 v[114:115], v127 offset:16896
    v_mfma_f32_16x16x32_bf16 v[44:47], v[116:119], v[92:95], v[44:47]
    v_mfma_f32_16x16x32_bf16 v[48:51], v[116:119], v[96:99], v[48:51]
    v_mfma_f32_16x16x32_bf16 v[52:55], v[116:119], v[100:103], v[52:55]
    v_mfma_f32_16x16x32_bf16 v[56:59], v[116:119], v[104:107], v[56:59]
    ds_read_b64_tr_b16 v[116:117], v128 offset:16384
    ds_read_b64_tr_b16 v[118:119], v128 offset:16896
    v_mfma_f32_16x16x32_bf16 v[60:63], v[120:123], v[92:95], v[60:63]
    v_mfma_f32_16x16x32_bf16 v[64:67], v[120:123], v[96:99], v[64:67]
    v_mfma_f32_16x16x32_bf16 v[68:71], v[120:123], v[100:103], v[68:71]
    v_mfma_f32_16x16x32_bf16 v[72:75], v[120:123], v[104:107], v[72:75]
    ds_read_b64_tr_b16 v[120:121], v129 offset:16384
    ds_read_b64_tr_b16 v[122:123], v129 offset:16896
    s_waitcnt lgkmcnt(6)
    v_mfma_f32_16x16x32_bf16 v[12:15], v[108:111], v[76:79], v[12:15]
    v_mfma_f32_16x16x32_bf16 v[16:19], v[108:111], v[80:83], v[16:19]
    v_mfma_f32_16x16x32_bf16 v[20:23], v[108:111], v[84:87], v[20:23]
    v_mfma_f32_16x16x32_bf16 v[24:27], v[108:111], v[88:91], v[24:27]
    s_waitcnt lgkmcnt(4)
    v_mfma_f32_16x16x32_bf16 v[28:31], v[112:115], v[76:79], v[28:31]
    ds_read_b64_tr_b16 v[108:109], v126 offset:20480
    ds_read_b64_tr_b16 v[110:111], v126 offset:20992
    v_mfma_f32_16x16x32_bf16 v[32:35], v[112:115], v[80:83], v[32:35]
    ds_read_b128 v[92:95], v125 offset:32768
    ds_read_b128 v[96:99], v125 offset:34816
    v_mfma_f32_16x16x32_bf16 v[36:39], v[112:115], v[84:87], v[36:39]
    ds_read_b128 v[100:103], v125 offset:36864
    ds_read_b128 v[104:107], v125 offset:38912
    v_mfma_f32_16x16x32_bf16 v[40:43], v[112:115], v[88:91], v[40:43]
    ds_read_b64_tr_b16 v[112:113], v127 offset:20480
    ds_read_b64_tr_b16 v[114:115], v127 offset:20992
    s_waitcnt lgkmcnt(10)
    v_mfma_f32_16x16x32_bf16 v[44:47], v[116:119], v[76:79], v[44:47]
    v_mfma_f32_16x16x32_bf16 v[48:51], v[116:119], v[80:83], v[48:51]
    v_mfma_f32_16x16x32_bf16 v[52:55], v[116:119], v[84:87], v[52:55]
    v_mfma_f32_16x16x32_bf16 v[56:59], v[116:119], v[88:91], v[56:59]
    ds_read_b64_tr_b16 v[116:117], v128 offset:20480
    ds_read_b64_tr_b16 v[118:119], v128 offset:20992
    s_waitcnt lgkmcnt(10)
    v_mfma_f32_16x16x32_bf16 v[60:63], v[120:123], v[76:79], v[60:63]
    v_mfma_f32_16x16x32_bf16 v[64:67], v[120:123], v[80:83], v[64:67]
    v_mfma_f32_16x16x32_bf16 v[68:71], v[120:123], v[84:87], v[68:71]
    v_mfma_f32_16x16x32_bf16 v[72:75], v[120:123], v[88:91], v[72:75]
    ds_read_b64_tr_b16 v[120:121], v129 offset:20480
    ds_read_b64_tr_b16 v[122:123], v129 offset:20992
    s_waitcnt lgkmcnt(6)
    v_mfma_f32_16x16x32_bf16 v[12:15], v[108:111], v[92:95], v[12:15]
    v_mfma_f32_16x16x32_bf16 v[16:19], v[108:111], v[96:99], v[16:19]
    v_mfma_f32_16x16x32_bf16 v[20:23], v[108:111], v[100:103], v[20:23]
    v_mfma_f32_16x16x32_bf16 v[24:27], v[108:111], v[104:107], v[24:27]
    s_waitcnt lgkmcnt(0)
    s_barrier
    v_mfma_f32_16x16x32_bf16 v[28:31], v[112:115], v[92:95], v[28:31]
    ds_read_b64_tr_b16 v[108:109], v126 offset:0
    ds_read_b64_tr_b16 v[110:111], v126 offset:512
    v_mfma_f32_16x16x32_bf16 v[32:35], v[112:115], v[96:99], v[32:35]
    ds_read_b128 v[76:79], v124 offset:0
    ds_read_b128 v[80:83], v124 offset:2048
    v_mfma_f32_16x16x32_bf16 v[36:39], v[112:115], v[100:103], v[36:39]
    ds_read_b128 v[84:87], v124 offset:4096
    ds_read_b128 v[88:91], v124 offset:6144
    v_mfma_f32_16x16x32_bf16 v[40:43], v[112:115], v[104:107], v[40:43]
    ds_read_b64_tr_b16 v[112:113], v127 offset:0
    ds_read_b64_tr_b16 v[114:115], v127 offset:512
    v_mfma_f32_16x16x32_bf16 v[44:47], v[116:119], v[92:95], v[44:47]
    v_mfma_f32_16x16x32_bf16 v[48:51], v[116:119], v[96:99], v[48:51]
    v_mfma_f32_16x16x32_bf16 v[52:55], v[116:119], v[100:103], v[52:55]
    v_mfma_f32_16x16x32_bf16 v[56:59], v[116:119], v[104:107], v[56:59]
    ds_read_b64_tr_b16 v[116:117], v128 offset:0
    ds_read_b64_tr_b16 v[118:119], v128 offset:512
    v_mfma_f32_16x16x32_bf16 v[60:63], v[120:123], v[92:95], v[60:63]
    v_mfma_f32_16x16x32_bf16 v[64:67], v[120:123], v[96:99], v[64:67]
    v_mfma_f32_16x16x32_bf16 v[68:71], v[120:123], v[100:103], v[68:71]
    v_mfma_f32_16x16x32_bf16 v[72:75], v[120:123], v[104:107], v[72:75]
    ds_read_b64_tr_b16 v[120:121], v129 offset:0
    ds_read_b64_tr_b16 v[122:123], v129 offset:512
    s_waitcnt lgkmcnt(6)
    v_mfma_f32_16x16x32_bf16 v[12:15], v[108:111], v[76:79], v[12:15]
    v_mfma_f32_16x16x32_bf16 v[16:19], v[108:111], v[80:83], v[16:19]
    v_mfma_f32_16x16x32_bf16 v[20:23], v[108:111], v[84:87], v[20:23]
    v_mfma_f32_16x16x32_bf16 v[24:27], v[108:111], v[88:91], v[24:27]
    s_waitcnt lgkmcnt(4)
    v_mfma_f32_16x16x32_bf16 v[28:31], v[112:115], v[76:79], v[28:31]
    ds_read_b64_tr_b16 v[108:109], v126 offset:4096
    ds_read_b64_tr_b16 v[110:111], v126 offset:4608
    v_mfma_f32_16x16x32_bf16 v[32:35], v[112:115], v[80:83], v[32:35]
    ds_read_b128 v[92:95], v125 offset:0
    ds_read_b128 v[96:99], v125 offset:2048
    v_mfma_f32_16x16x32_bf16 v[36:39], v[112:115], v[84:87], v[36:39]
    ds_read_b128 v[100:103], v125 offset:4096
    ds_read_b128 v[104:107], v125 offset:6144
    v_mfma_f32_16x16x32_bf16 v[40:43], v[112:115], v[88:91], v[40:43]
    ds_read_b64_tr_b16 v[112:113], v127 offset:4096
    ds_read_b64_tr_b16 v[114:115], v127 offset:4608
    s_waitcnt lgkmcnt(10)
    v_mfma_f32_16x16x32_bf16 v[44:47], v[116:119], v[76:79], v[44:47]
    v_mfma_f32_16x16x32_bf16 v[48:51], v[116:119], v[80:83], v[48:51]
    v_mfma_f32_16x16x32_bf16 v[52:55], v[116:119], v[84:87], v[52:55]
    v_mfma_f32_16x16x32_bf16 v[56:59], v[116:119], v[88:91], v[56:59]
    ds_read_b64_tr_b16 v[116:117], v128 offset:4096
    ds_read_b64_tr_b16 v[118:119], v128 offset:4608
    s_waitcnt lgkmcnt(10)
    v_mfma_f32_16x16x32_bf16 v[60:63], v[120:123], v[76:79], v[60:63]
    v_mfma_f32_16x16x32_bf16 v[64:67], v[120:123], v[80:83], v[64:67]
    v_mfma_f32_16x16x32_bf16 v[68:71], v[120:123], v[84:87], v[68:71]
    v_mfma_f32_16x16x32_bf16 v[72:75], v[120:123], v[88:91], v[72:75]
    ds_read_b64_tr_b16 v[120:121], v129 offset:4096
    ds_read_b64_tr_b16 v[122:123], v129 offset:4608
    s_waitcnt lgkmcnt(6)
    v_mfma_f32_16x16x32_bf16 v[12:15], v[108:111], v[92:95], v[12:15]
    v_mfma_f32_16x16x32_bf16 v[16:19], v[108:111], v[96:99], v[16:19]
    v_mfma_f32_16x16x32_bf16 v[20:23], v[108:111], v[100:103], v[20:23]
    v_mfma_f32_16x16x32_bf16 v[24:27], v[108:111], v[104:107], v[24:27]
    s_waitcnt lgkmcnt(0)
    s_barrier
    v_mfma_f32_16x16x32_bf16 v[28:31], v[112:115], v[92:95], v[28:31]
    ds_read_b64_tr_b16 v[108:109], v126 offset:8192
    ds_read_b64_tr_b16 v[110:111], v126 offset:8704
    v_mfma_f32_16x16x32_bf16 v[32:35], v[112:115], v[96:99], v[32:35]
    ds_read_b128 v[76:79], v124 offset:16384
    ds_read_b128 v[80:83], v124 offset:18432
    v_mfma_f32_16x16x32_bf16 v[36:39], v[112:115], v[100:103], v[36:39]
    ds_read_b128 v[84:87], v124 offset:20480
    ds_read_b128 v[88:91], v124 offset:22528
    v_mfma_f32_16x16x32_bf16 v[40:43], v[112:115], v[104:107], v[40:43]
    ds_read_b64_tr_b16 v[112:113], v127 offset:8192
    ds_read_b64_tr_b16 v[114:115], v127 offset:8704
    v_mfma_f32_16x16x32_bf16 v[44:47], v[116:119], v[92:95], v[44:47]
    v_mfma_f32_16x16x32_bf16 v[48:51], v[116:119], v[96:99], v[48:51]
    v_mfma_f32_16x16x32_bf16 v[52:55], v[116:119], v[100:103], v[52:55]
    v_mfma_f32_16x16x32_bf16 v[56:59], v[116:119], v[104:107], v[56:59]
    ds_read_b64_tr_b16 v[116:117], v128 offset:8192
    ds_read_b64_tr_b16 v[118:119], v128 offset:8704
    v_mfma_f32_16x16x32_bf16 v[60:63], v[120:123], v[92:95], v[60:63]
    v_mfma_f32_16x16x32_bf16 v[64:67], v[120:123], v[96:99], v[64:67]
    v_mfma_f32_16x16x32_bf16 v[68:71], v[120:123], v[100:103], v[68:71]
    v_mfma_f32_16x16x32_bf16 v[72:75], v[120:123], v[104:107], v[72:75]
    ds_read_b64_tr_b16 v[120:121], v129 offset:8192
    ds_read_b64_tr_b16 v[122:123], v129 offset:8704
    s_waitcnt lgkmcnt(6)
    v_mfma_f32_16x16x32_bf16 v[12:15], v[108:111], v[76:79], v[12:15]
    v_mfma_f32_16x16x32_bf16 v[16:19], v[108:111], v[80:83], v[16:19]
    v_mfma_f32_16x16x32_bf16 v[20:23], v[108:111], v[84:87], v[20:23]
    v_mfma_f32_16x16x32_bf16 v[24:27], v[108:111], v[88:91], v[24:27]
    s_waitcnt lgkmcnt(4)
    v_mfma_f32_16x16x32_bf16 v[28:31], v[112:115], v[76:79], v[28:31]
    ds_read_b64_tr_b16 v[108:109], v126 offset:12288
    ds_read_b64_tr_b16 v[110:111], v126 offset:12800
    v_mfma_f32_16x16x32_bf16 v[32:35], v[112:115], v[80:83], v[32:35]
    ds_read_b128 v[92:95], v125 offset:16384
    ds_read_b128 v[96:99], v125 offset:18432
    v_mfma_f32_16x16x32_bf16 v[36:39], v[112:115], v[84:87], v[36:39]
    ds_read_b128 v[100:103], v125 offset:20480
    ds_read_b128 v[104:107], v125 offset:22528
    v_mfma_f32_16x16x32_bf16 v[40:43], v[112:115], v[88:91], v[40:43]
    ds_read_b64_tr_b16 v[112:113], v127 offset:12288
    ds_read_b64_tr_b16 v[114:115], v127 offset:12800
    s_waitcnt lgkmcnt(10)
    v_mfma_f32_16x16x32_bf16 v[44:47], v[116:119], v[76:79], v[44:47]
    v_mfma_f32_16x16x32_bf16 v[48:51], v[116:119], v[80:83], v[48:51]
    v_mfma_f32_16x16x32_bf16 v[52:55], v[116:119], v[84:87], v[52:55]
    v_mfma_f32_16x16x32_bf16 v[56:59], v[116:119], v[88:91], v[56:59]
    ds_read_b64_tr_b16 v[116:117], v128 offset:12288
    ds_read_b64_tr_b16 v[118:119], v128 offset:12800
    s_waitcnt lgkmcnt(10)
    v_mfma_f32_16x16x32_bf16 v[60:63], v[120:123], v[76:79], v[60:63]
    v_mfma_f32_16x16x32_bf16 v[64:67], v[120:123], v[80:83], v[64:67]
    v_mfma_f32_16x16x32_bf16 v[68:71], v[120:123], v[84:87], v[68:71]
    v_mfma_f32_16x16x32_bf16 v[72:75], v[120:123], v[88:91], v[72:75]
    ds_read_b64_tr_b16 v[120:121], v129 offset:12288
    ds_read_b64_tr_b16 v[122:123], v129 offset:12800
    s_waitcnt lgkmcnt(6)
    v_mfma_f32_16x16x32_bf16 v[12:15], v[108:111], v[92:95], v[12:15]
    v_mfma_f32_16x16x32_bf16 v[16:19], v[108:111], v[96:99], v[16:19]
    v_mfma_f32_16x16x32_bf16 v[20:23], v[108:111], v[100:103], v[20:23]
    v_mfma_f32_16x16x32_bf16 v[24:27], v[108:111], v[104:107], v[24:27]
    s_waitcnt lgkmcnt(0)
    s_barrier
    v_mfma_f32_16x16x32_bf16 v[28:31], v[112:115], v[92:95], v[28:31]
    ds_read_b64_tr_b16 v[108:109], v126 offset:16384
    ds_read_b64_tr_b16 v[110:111], v126 offset:16896
    v_mfma_f32_16x16x32_bf16 v[32:35], v[112:115], v[96:99], v[32:35]
    ds_read_b128 v[76:79], v124 offset:32768
    ds_read_b128 v[80:83], v124 offset:34816
    v_mfma_f32_16x16x32_bf16 v[36:39], v[112:115], v[100:103], v[36:39]
    ds_read_b128 v[84:87], v124 offset:36864
    ds_read_b128 v[88:91], v124 offset:38912
    v_mfma_f32_16x16x32_bf16 v[40:43], v[112:115], v[104:107], v[40:43]
    ds_read_b64_tr_b16 v[112:113], v127 offset:16384
    ds_read_b64_tr_b16 v[114:115], v127 offset:16896
    v_mfma_f32_16x16x32_bf16 v[44:47], v[116:119], v[92:95], v[44:47]
    v_mfma_f32_16x16x32_bf16 v[48:51], v[116:119], v[96:99], v[48:51]
    v_mfma_f32_16x16x32_bf16 v[52:55], v[116:119], v[100:103], v[52:55]
    v_mfma_f32_16x16x32_bf16 v[56:59], v[116:119], v[104:107], v[56:59]
    ds_read_b64_tr_b16 v[116:117], v128 offset:16384
    ds_read_b64_tr_b16 v[118:119], v128 offset:16896
    v_mfma_f32_16x16x32_bf16 v[60:63], v[120:123], v[92:95], v[60:63]
    v_mfma_f32_16x16x32_bf16 v[64:67], v[120:123], v[96:99], v[64:67]
    v_mfma_f32_16x16x32_bf16 v[68:71], v[120:123], v[100:103], v[68:71]
    v_mfma_f32_16x16x32_bf16 v[72:75], v[120:123], v[104:107], v[72:75]
    ds_read_b64_tr_b16 v[120:121], v129 offset:16384
    ds_read_b64_tr_b16 v[122:123], v129 offset:16896
    s_waitcnt lgkmcnt(6)
    v_mfma_f32_16x16x32_bf16 v[12:15], v[108:111], v[76:79], v[12:15]
    v_mfma_f32_16x16x32_bf16 v[16:19], v[108:111], v[80:83], v[16:19]
    v_mfma_f32_16x16x32_bf16 v[20:23], v[108:111], v[84:87], v[20:23]
    v_mfma_f32_16x16x32_bf16 v[24:27], v[108:111], v[88:91], v[24:27]
    s_waitcnt lgkmcnt(4)
    v_mfma_f32_16x16x32_bf16 v[28:31], v[112:115], v[76:79], v[28:31]
    ds_read_b64_tr_b16 v[108:109], v126 offset:20480
    ds_read_b64_tr_b16 v[110:111], v126 offset:20992
    v_mfma_f32_16x16x32_bf16 v[32:35], v[112:115], v[80:83], v[32:35]
    ds_read_b128 v[92:95], v125 offset:32768
    ds_read_b128 v[96:99], v125 offset:34816
    v_mfma_f32_16x16x32_bf16 v[36:39], v[112:115], v[84:87], v[36:39]
    ds_read_b128 v[100:103], v125 offset:36864
    ds_read_b128 v[104:107], v125 offset:38912
    v_mfma_f32_16x16x32_bf16 v[40:43], v[112:115], v[88:91], v[40:43]
    ds_read_b64_tr_b16 v[112:113], v127 offset:20480
    ds_read_b64_tr_b16 v[114:115], v127 offset:20992
    s_waitcnt lgkmcnt(10)
    v_mfma_f32_16x16x32_bf16 v[44:47], v[116:119], v[76:79], v[44:47]
    v_mfma_f32_16x16x32_bf16 v[48:51], v[116:119], v[80:83], v[48:51]
    v_mfma_f32_16x16x32_bf16 v[52:55], v[116:119], v[84:87], v[52:55]
    v_mfma_f32_16x16x32_bf16 v[56:59], v[116:119], v[88:91], v[56:59]
    ds_read_b64_tr_b16 v[116:117], v128 offset:20480
    ds_read_b64_tr_b16 v[118:119], v128 offset:20992
    s_waitcnt lgkmcnt(10)
    v_mfma_f32_16x16x32_bf16 v[60:63], v[120:123], v[76:79], v[60:63]
    v_mfma_f32_16x16x32_bf16 v[64:67], v[120:123], v[80:83], v[64:67]
    v_mfma_f32_16x16x32_bf16 v[68:71], v[120:123], v[84:87], v[68:71]
    v_mfma_f32_16x16x32_bf16 v[72:75], v[120:123], v[88:91], v[72:75]
    ds_read_b64_tr_b16 v[120:121], v129 offset:20480
    ds_read_b64_tr_b16 v[122:123], v129 offset:20992
    s_waitcnt lgkmcnt(6)
    v_mfma_f32_16x16x32_bf16 v[12:15], v[108:111], v[92:95], v[12:15]
    v_mfma_f32_16x16x32_bf16 v[16:19], v[108:111], v[96:99], v[16:19]
    v_mfma_f32_16x16x32_bf16 v[20:23], v[108:111], v[100:103], v[20:23]
    v_mfma_f32_16x16x32_bf16 v[24:27], v[108:111], v[104:107], v[24:27]
    s_waitcnt lgkmcnt(0)
    s_barrier
    s_cmp_eq_u32 s57, 0
    s_cbranch_scc1 nqp_13
    s_setprio 2
nqp_13:
    v_mfma_f32_16x16x32_bf16 v[28:31], v[112:115], v[92:95], v[28:31]
    ds_read_b64_tr_b16 v[108:109], v126 offset:0
    ds_read_b64_tr_b16 v[110:111], v126 offset:512
    v_mfma_f32_16x16x32_bf16 v[32:35], v[112:115], v[96:99], v[32:35]
    ds_read_b128 v[76:79], v124 offset:0
    ds_read_b128 v[80:83], v124 offset:2048
    v_and_b32 v6, 15, v1
    v_mfma_f32_16x16x32_bf16 v[36:39], v[112:115], v[100:103], v[36:39]
    ds_read_b128 v[84:87], v124 offset:4096
    ds_read_b128 v[88:91], v124 offset:6144
    v_lshrrev_b32 v7, 4, v1
    v_mfma_f32_16x16x32_bf16 v[40:43], v[112:115], v[104:107], v[40:43]
    ds_read_b64_tr_b16 v[112:113], v127 offset:0
    ds_read_b64_tr_b16 v[114:115], v127 offset:512
    s_lshl_b32 s44, s25, 10
    v_mfma_f32_16x16x32_bf16 v[44:47], v[116:119], v[92:95], v[44:47]
    s_add_u32 s44, s44, 156672
    v_mfma_f32_16x16x32_bf16 v[48:51], v[116:119], v[96:99], v[48:51]
    v_mfma_f32_16x16x32_bf16 v[52:55], v[116:119], v[100:103], v[52:55]
    v_lshl_add_u32 v4, v6, 4, s44
    v_mfma_f32_16x16x32_bf16 v[56:59], v[116:119], v[104:107], v[56:59]
    ds_read_b64_tr_b16 v[116:117], v128 offset:0
    ds_read_b64_tr_b16 v[118:119], v128 offset:512
    s_lshl_b32 s44, s26, 8
    v_mfma_f32_16x16x32_bf16 v[60:63], v[120:123], v[92:95], v[60:63]
    s_add_u32 s44, s44, 16384
    v_mfma_f32_16x16x32_bf16 v[64:67], v[120:123], v[96:99], v[64:67]
    v_lshl_add_u32 v5, v6, 2, s44
    v_mfma_f32_16x16x32_bf16 v[68:71], v[120:123], v[100:103], v[68:71]
    v_mfma_f32_16x16x32_bf16 v[72:75], v[120:123], v[104:107], v[72:75]
    ds_read_b64_tr_b16 v[120:121], v129 offset:0
    ds_read_b64_tr_b16 v[122:123], v129 offset:512
    v_lshl_add_u32 v5, v7, 12, v5
    s_waitcnt lgkmcnt(6)
    v_mfma_f32_16x16x32_bf16 v[12:15], v[108:111], v[76:79], v[12:15]
    v_lshlrev_b32 v131, 4, v6
    v_mfma_f32_16x16x32_bf16 v[16:19], v[108:111], v[80:83], v[16:19]
    v_lshl_add_u32 v131, v7, 9, v131
    v_mfma_f32_16x16x32_bf16 v[20:23], v[108:111], v[84:87], v[20:23]
    ds_read_b128 v[132:135], v4 offset:0
    v_mfma_f32_16x16x32_bf16 v[24:27], v[108:111], v[88:91], v[24:27]
    ds_read_b128 v[136:139], v4 offset:256
    s_waitcnt lgkmcnt(4)
    v_mfma_f32_16x16x32_bf16 v[28:31], v[112:115], v[76:79], v[28:31]
    ds_read_b64_tr_b16 v[108:109], v126 offset:4096
    ds_read_b64_tr_b16 v[110:111], v126 offset:4608
    v_mfma_f32_16x16x32_bf16 v[32:35], v[112:115], v[80:83], v[32:35]
    ds_read_b128 v[92:95], v125 offset:0
    ds_read_b128 v[96:99], v125 offset:2048
    ds_read_b128 v[140:143], v4 offset:512
    v_mfma_f32_16x16x32_bf16 v[36:39], v[112:115], v[84:87], v[36:39]
    ds_read_b128 v[100:103], v125 offset:4096
    ds_read_b128 v[104:107], v125 offset:6144
    ds_read_b128 v[144:147], v4 offset:768
    v_mfma_f32_16x16x32_bf16 v[40:43], v[112:115], v[88:91], v[40:43]
    ds_read_b64_tr_b16 v[112:113], v127 offset:4096
    ds_read_b64_tr_b16 v[114:115], v127 offset:4608
    ds_read2st64_b32 v[148:149], v5 offset0:0 offset1:4
    s_waitcnt lgkmcnt(10)
    v_mfma_f32_16x16x32_bf16 v[44:47], v[116:119], v[76:79], v[44:47]
    ds_read2st64_b32 v[150:151], v5 offset0:8 offset1:12
    v_mfma_f32_16x16x32_bf16 v[48:51], v[116:119], v[80:83], v[48:51]
    v_mfma_f32_16x16x32_bf16 v[52:55], v[116:119], v[84:87], v[52:55]
    v_add_u32 v5, 64, v5
    v_mfma_f32_16x16x32_bf16 v[56:59], v[116:119], v[88:91], v[56:59]
    ds_read_b64_tr_b16 v[116:117], v128 offset:4096
    ds_read_b64_tr_b16 v[118:119], v128 offset:4608
    ds_read2st64_b32 v[152:153], v5 offset0:0 offset1:4
    s_waitcnt lgkmcnt(10)
    v_mfma_f32_16x16x32_bf16 v[60:63], v[120:123], v[76:79], v[60:63]
    ds_read2st64_b32 v[154:155], v5 offset0:8 offset1:12
    v_mfma_f32_16x16x32_bf16 v[64:67], v[120:123], v[80:83], v[64:67]
    v_add_u32 v5, 64, v5
    v_mfma_f32_16x16x32_bf16 v[68:71], v[120:123], v[84:87], v[68:71]
    v_mfma_f32_16x16x32_bf16 v[72:75], v[120:123], v[88:91], v[72:75]
    ds_read_b64_tr_b16 v[120:121], v129 offset:4096
    ds_read_b64_tr_b16 v[122:123], v129 offset:4608
    ds_read2st64_b32 v[156:157], v5 offset0:0 offset1:4
    s_waitcnt lgkmcnt(6)
    v_mfma_f32_16x16x32_bf16 v[12:15], v[108:111], v[92:95], v[12:15]
    ds_read2st64_b32 v[158:159], v5 offset0:8 offset1:12
    v_mfma_f32_16x16x32_bf16 v[16:19], v[108:111], v[96:99], v[16:19]
    v_add_u32 v5, 64, v5
    v_mfma_f32_16x16x32_bf16 v[20:23], v[108:111], v[100:103], v[20:23]
    ds_read2st64_b32 v[160:161], v5 offset0:0 offset1:4
    v_mfma_f32_16x16x32_bf16 v[24:27], v[108:111], v[104:107], v[24:27]
    ds_read2st64_b32 v[162:163], v5 offset0:8 offset1:12
    s_lshl_b32 s44, s24, 2
    s_add_u32 s44, s44, 160832
    v_mov_b32 v4, s44
    v_mov_b32 v5, s98
    s_waitcnt lgkmcnt(0)
    ds_write_b32 v4, v5
    v_mfma_f32_16x16x32_bf16 v[28:31], v[112:115], v[92:95], v[28:31]
    v_mov_b32 v76, v132
    v_mfma_f32_16x16x32_bf16 v[32:35], v[112:115], v[96:99], v[32:35]
    v_mov_b32 v77, v132
    v_mfma_f32_16x16x32_bf16 v[36:39], v[112:115], v[100:103], v[36:39]
    v_mov_b32 v78, v132
    v_mov_b32 v79, v132
    v_mfma_f32_16x16x32_bf16 v[40:43], v[112:115], v[104:107], v[40:43]
    v_mov_b32 v80, v136
    v_mfma_f32_16x16x32_bf16 v[44:47], v[116:119], v[92:95], v[44:47]
    v_mov_b32 v81, v136
    v_mfma_f32_16x16x32_bf16 v[48:51], v[116:119], v[96:99], v[48:51]
    v_mov_b32 v82, v136
    v_mov_b32 v83, v136
    v_mfma_f32_16x16x32_bf16 v[52:55], v[116:119], v[100:103], v[52:55]
    v_mov_b32 v84, v140
    v_mfma_f32_16x16x32_bf16 v[56:59], v[116:119], v[104:107], v[56:59]
    v_mov_b32 v85, v140
    v_mfma_f32_16x16x32_bf16 v[60:63], v[120:123], v[92:95], v[60:63]
    v_mov_b32 v86, v140
    v_mov_b32 v87, v140
    v_mfma_f32_16x16x32_bf16 v[64:67], v[120:123], v[96:99], v[64:67]
    v_mov_b32 v88, v144
    v_mfma_f32_16x16x32_bf16 v[68:71], v[120:123], v[100:103], v[68:71]
    v_mov_b32 v89, v144
    v_mfma_f32_16x16x32_bf16 v[72:75], v[120:123], v[104:107], v[72:75]
    v_mov_b32 v90, v144
    v_mov_b32 v91, v144
    s_mov_b32 s46, 3222493025
    s_mov_b32 s47, 3184710632
    v_mfma_f32_16x16x32_bf16 v[12:15], v[148:151], v[76:79], v[12:15]
    v_mfma_f32_16x16x32_bf16 v[28:31], v[152:155], v[76:79], v[28:31]
    v_mfma_f32_16x16x32_bf16 v[44:47], v[156:159], v[76:79], v[44:47]
    v_mfma_f32_16x16x32_bf16 v[60:63], v[160:163], v[76:79], v[60:63]
    v_mfma_f32_16x16x32_bf16 v[16:19], v[148:151], v[80:83], v[16:19]
    v_mfma_f32_16x16x32_bf16 v[32:35], v[152:155], v[80:83], v[32:35]
    v_mfma_f32_16x16x32_bf16 v[48:51], v[156:159], v[80:83], v[48:51]
    v_mfma_f32_16x16x32_bf16 v[64:67], v[160:163], v[80:83], v[64:67]
    v_mfma_f32_16x16x32_bf16 v[20:23], v[148:151], v[84:87], v[20:23]
    v_mfma_f32_16x16x32_bf16 v[36:39], v[152:155], v[84:87], v[36:39]
    v_mfma_f32_16x16x32_bf16 v[52:55], v[156:159], v[84:87], v[52:55]
    v_mfma_f32_16x16x32_bf16 v[68:71], v[160:163], v[84:87], v[68:71]
    v_mfma_f32_16x16x32_bf16 v[24:27], v[148:151], v[88:91], v[24:27]
    v_mfma_f32_16x16x32_bf16 v[40:43], v[152:155], v[88:91], v[40:43]
    v_mfma_f32_16x16x32_bf16 v[56:59], v[156:159], v[88:91], v[56:59]
    v_mfma_f32_16x16x32_bf16 v[72:75], v[160:163], v[88:91], v[72:75]
    s_lshl_b32 s44, s27, 2
    s_lshl_b32 s45, s25, 1
    s_add_u32 s60, s44, s45
    s_cmp_eq_u32 s57, 1
    s_cbranch_scc1 qepi_14
    s_lshr_b32 s44, s49, 4
    s_lshl_b32 s45, s26, 1
    s_add_u32 s44, s44, s45
    s_mul_i32 s42, s60, 108
    s_add_u32 s42, s42, s44
    s_lshl_b32 s42, s42, 10
    s_add_u32 s43, s42, 110592
    v_mul_f32 v4, s46, v133
    v_mul_f32 v5, s46, v133
    v_mul_f32 v8, v133, v133
    v_mov_b32 v135, v134
    v_mul_f32 v8, v8, v133
    v_mul_f32 v6, s47, v8
    v_mul_f32 v7, s47, v8
    v_pk_mul_f32 v[92:93], v[12:13], v[12:13]
    v_pk_mul_f32 v[94:95], v[14:15], v[14:15]
    v_pk_mul_f32 v[96:97], v[44:45], v[44:45]
    v_pk_mul_f32 v[98:99], v[46:47], v[46:47]
    v_pk_fma_f32 v[92:93], v[92:93], v[6:7], v[4:5]
    v_pk_fma_f32 v[94:95], v[94:95], v[6:7], v[4:5]
    v_pk_fma_f32 v[96:97], v[96:97], v[6:7], v[4:5]
    v_pk_fma_f32 v[98:99], v[98:99], v[6:7], v[4:5]
    v_pk_mul_f32 v[92:93], v[92:93], v[12:13]
    v_pk_mul_f32 v[94:95], v[94:95], v[14:15]
    v_pk_mul_f32 v[96:97], v[96:97], v[44:45]
    v_pk_mul_f32 v[98:99], v[98:99], v[46:47]
    v_exp_f32 v92, v92
    v_exp_f32 v93, v93
    v_exp_f32 v94, v94
    v_exp_f32 v95, v95
    v_exp_f32 v96, v96
    v_exp_f32 v97, v97
    v_exp_f32 v98, v98
    v_exp_f32 v99, v99
    v_pk_mul_f32 v[108:109], v[12:13], v[28:29]
    v_pk_mul_f32 v[110:111], v[14:15], v[30:31]
    v_pk_mul_f32 v[112:113], v[44:45], v[60:61]
    v_pk_mul_f32 v[114:115], v[46:47], v[62:63]
    v_pk_fma_f32 v[92:93], v[92:93], v[134:135], v[134:135]
    v_pk_fma_f32 v[94:95], v[94:95], v[134:135], v[134:135]
    v_pk_fma_f32 v[96:97], v[96:97], v[134:135], v[134:135]
    v_pk_fma_f32 v[98:99], v[98:99], v[134:135], v[134:135]
    v_rcp_f32 v92, v92
    v_rcp_f32 v93, v93
    v_rcp_f32 v94, v94
    v_rcp_f32 v95, v95
    v_rcp_f32 v96, v96
    v_rcp_f32 v97, v97
    v_rcp_f32 v98, v98
    v_rcp_f32 v99, v99
    s_nop 0
    v_pk_mul_f32 v[108:109], v[108:109], v[92:93]
    v_pk_mul_f32 v[110:111], v[110:111], v[94:95]
    v_pk_mul_f32 v[112:113], v[112:113], v[96:97]
    v_pk_mul_f32 v[114:115], v[114:115], v[98:99]
    v_cvt_pk_bf16_f32 v148, v108, v109
    v_cvt_pk_bf16_f32 v149, v110, v111
    v_cvt_pk_bf16_f32 v150, v112, v113
    v_cvt_pk_bf16_f32 v151, v114, v115
    v_mul_f32 v4, s46, v137
    v_mul_f32 v5, s46, v137
    v_mul_f32 v8, v137, v137
    v_mov_b32 v139, v138
    v_mul_f32 v8, v8, v137
    v_mul_f32 v6, s47, v8
    v_mul_f32 v7, s47, v8
    v_pk_mul_f32 v[100:101], v[16:17], v[16:17]
    v_pk_mul_f32 v[102:103], v[18:19], v[18:19]
    v_pk_mul_f32 v[104:105], v[48:49], v[48:49]
    v_pk_mul_f32 v[106:107], v[50:51], v[50:51]
    v_pk_fma_f32 v[100:101], v[100:101], v[6:7], v[4:5]
    v_pk_fma_f32 v[102:103], v[102:103], v[6:7], v[4:5]
    v_pk_fma_f32 v[104:105], v[104:105], v[6:7], v[4:5]
    v_pk_fma_f32 v[106:107], v[106:107], v[6:7], v[4:5]
    v_pk_mul_f32 v[100:101], v[100:101], v[16:17]
    v_pk_mul_f32 v[102:103], v[102:103], v[18:19]
    v_pk_mul_f32 v[104:105], v[104:105], v[48:49]
    v_pk_mul_f32 v[106:107], v[106:107], v[50:51]
    v_exp_f32 v100, v100
    v_exp_f32 v101, v101
    v_exp_f32 v102, v102
    v_exp_f32 v103, v103
    v_exp_f32 v104, v104
    v_exp_f32 v105, v105
    v_exp_f32 v106, v106
    v_exp_f32 v107, v107
    v_pk_mul_f32 v[116:117], v[16:17], v[32:33]
    v_pk_mul_f32 v[118:119], v[18:19], v[34:35]
    v_pk_mul_f32 v[120:121], v[48:49], v[64:65]
    v_pk_mul_f32 v[122:123], v[50:51], v[66:67]
    v_pk_fma_f32 v[100:101], v[100:101], v[138:139], v[138:139]
    v_pk_fma_f32 v[102:103], v[102:103], v[138:139], v[138:139]
    v_pk_fma_f32 v[104:105], v[104:105], v[138:139], v[138:139]
    v_pk_fma_f32 v[106:107], v[106:107], v[138:139], v[138:139]
    v_rcp_f32 v100, v100
    v_rcp_f32 v101, v101
    v_rcp_f32 v102, v102
    v_rcp_f32 v103, v103
    v_rcp_f32 v104, v104
    v_rcp_f32 v105, v105
    v_rcp_f32 v106, v106
    v_rcp_f32 v107, v107
    s_nop 0
    v_pk_mul_f32 v[116:117], v[116:117], v[100:101]
    v_pk_mul_f32 v[118:119], v[118:119], v[102:103]
    v_pk_mul_f32 v[120:121], v[120:121], v[104:105]
    v_pk_mul_f32 v[122:123], v[122:123], v[106:107]
    v_cvt_pk_bf16_f32 v152, v116, v117
    v_cvt_pk_bf16_f32 v153, v118, v119
    v_cvt_pk_bf16_f32 v154, v120, v121
    v_cvt_pk_bf16_f32 v155, v122, v123
    v_mul_f32 v4, s46, v141
    v_mul_f32 v5, s46, v141
    v_mul_f32 v8, v141, v141
    v_mov_b32 v143, v142
    v_mul_f32 v8, v8, v141
    v_mul_f32 v6, s47, v8
    v_mul_f32 v7, s47, v8
    v_pk_mul_f32 v[92:93], v[20:21], v[20:21]
    v_pk_mul_f32 v[94:95], v[22:23], v[22:23]
    v_pk_mul_f32 v[96:97], v[52:53], v[52:53]
    v_pk_mul_f32 v[98:99], v[54:55], v[54:55]
    v_pk_fma_f32 v[92:93], v[92:93], v[6:7], v[4:5]
    v_pk_fma_f32 v[94:95], v[94:95], v[6:7], v[4:5]
    v_pk_fma_f32 v[96:97], v[96:97], v[6:7], v[4:5]
    v_pk_fma_f32 v[98:99], v[98:99], v[6:7], v[4:5]
    v_pk_mul_f32 v[92:93], v[92:93], v[20:21]
    v_pk_mul_f32 v[94:95], v[94:95], v[22:23]
    v_pk_mul_f32 v[96:97], v[96:97], v[52:53]
    v_pk_mul_f32 v[98:99], v[98:99], v[54:55]
    v_exp_f32 v92, v92
    v_exp_f32 v93, v93
    v_exp_f32 v94, v94
    v_exp_f32 v95, v95
    v_exp_f32 v96, v96
    v_exp_f32 v97, v97
    v_exp_f32 v98, v98
    v_exp_f32 v99, v99
    v_pk_mul_f32 v[108:109], v[20:21], v[36:37]
    v_pk_mul_f32 v[110:111], v[22:23], v[38:39]
    v_pk_mul_f32 v[112:113], v[52:53], v[68:69]
    v_pk_mul_f32 v[114:115], v[54:55], v[70:71]
    v_pk_fma_f32 v[92:93], v[92:93], v[142:143], v[142:143]
    v_pk_fma_f32 v[94:95], v[94:95], v[142:143], v[142:143]
    v_pk_fma_f32 v[96:97], v[96:97], v[142:143], v[142:143]
    v_pk_fma_f32 v[98:99], v[98:99], v[142:143], v[142:143]
    v_rcp_f32 v92, v92
    v_rcp_f32 v93, v93
    v_rcp_f32 v94, v94
    v_rcp_f32 v95, v95
    v_rcp_f32 v96, v96
    v_rcp_f32 v97, v97
    v_rcp_f32 v98, v98
    v_rcp_f32 v99, v99
    s_nop 0
    v_pk_mul_f32 v[108:109], v[108:109], v[92:93]
    v_pk_mul_f32 v[110:111], v[110:111], v[94:95]
    v_pk_mul_f32 v[112:113], v[112:113], v[96:97]
    v_pk_mul_f32 v[114:115], v[114:115], v[98:99]
    v_cvt_pk_bf16_f32 v156, v108, v109
    v_cvt_pk_bf16_f32 v157, v110, v111
    v_cvt_pk_bf16_f32 v158, v112, v113
    v_cvt_pk_bf16_f32 v159, v114, v115
    v_mul_f32 v4, s46, v145
    v_mul_f32 v5, s46, v145
    v_mul_f32 v8, v145, v145
    v_mov_b32 v147, v146
    v_mul_f32 v8, v8, v145
    v_mul_f32 v6, s47, v8
    v_mul_f32 v7, s47, v8
    v_pk_mul_f32 v[100:101], v[24:25], v[24:25]
    v_pk_mul_f32 v[102:103], v[26:27], v[26:27]
    v_pk_mul_f32 v[104:105], v[56:57], v[56:57]
    v_pk_mul_f32 v[106:107], v[58:59], v[58:59]
    v_pk_fma_f32 v[100:101], v[100:101], v[6:7], v[4:5]
    v_pk_fma_f32 v[102:103], v[102:103], v[6:7], v[4:5]
    v_pk_fma_f32 v[104:105], v[104:105], v[6:7], v[4:5]
    v_pk_fma_f32 v[106:107], v[106:107], v[6:7], v[4:5]
    v_pk_mul_f32 v[100:101], v[100:101], v[24:25]
    v_pk_mul_f32 v[102:103], v[102:103], v[26:27]
    v_pk_mul_f32 v[104:105], v[104:105], v[56:57]
    v_pk_mul_f32 v[106:107], v[106:107], v[58:59]
    v_exp_f32 v100, v100
    v_exp_f32 v101, v101
    v_exp_f32 v102, v102
    v_exp_f32 v103, v103
    v_exp_f32 v104, v104
    v_exp_f32 v105, v105
    v_exp_f32 v106, v106
    v_exp_f32 v107, v107
    v_pk_mul_f32 v[116:117], v[24:25], v[40:41]
    v_pk_mul_f32 v[118:119], v[26:27], v[42:43]
    v_pk_mul_f32 v[120:121], v[56:57], v[72:73]
    v_pk_mul_f32 v[122:123], v[58:59], v[74:75]
    v_pk_fma_f32 v[100:101], v[100:101], v[146:147], v[146:147]
    v_pk_fma_f32 v[102:103], v[102:103], v[146:147], v[146:147]
    v_pk_fma_f32 v[104:105], v[104:105], v[146:147], v[146:147]
    v_pk_fma_f32 v[106:107], v[106:107], v[146:147], v[146:147]
    v_rcp_f32 v100, v100
    v_rcp_f32 v101, v101
    v_rcp_f32 v102, v102
    v_rcp_f32 v103, v103
    v_rcp_f32 v104, v104
    v_rcp_f32 v105, v105
    v_rcp_f32 v106, v106
    v_rcp_f32 v107, v107
    s_nop 0
    v_pk_mul_f32 v[116:117], v[116:117], v[100:101]
    v_pk_mul_f32 v[118:119], v[118:119], v[102:103]
    v_pk_mul_f32 v[120:121], v[120:121], v[104:105]
    v_pk_mul_f32 v[122:123], v[122:123], v[106:107]
    v_cvt_pk_bf16_f32 v160, v116, v117
    v_cvt_pk_bf16_f32 v161, v118, v119
    v_cvt_pk_bf16_f32 v162, v120, v121
    v_cvt_pk_bf16_f32 v163, v122, v123
    s_branch epidone_15
qepi_14:
    s_sub_u32 s44, s26, 2
    s_lshl_b32 s44, s44, 6
    s_add_u32 s44, s44, s50
    s_lshl_b32 s44, s44, 6
    s_add_u32 s44, s44, 7340032
    s_mov_b32 s45, 1051011932
    s_mul_i32 s46, s60, 40960
    s_add_u32 s46, s46, s44
    s_add_u32 s47, s46, 40960
    v_mul_f32 v4, s45, v133
    v_mul_f32 v5, s45, v137
    v_mul_f32 v6, s45, v141
    v_mul_f32 v7, s45, v145
    v_mul_f32 v12, v12, v4
    v_mul_f32 v13, v13, v4
    v_mul_f32 v14, v14, v4
    v_mul_f32 v15, v15, v4
    v_mul_f32 v28, v28, v4
    v_mul_f32 v29, v29, v4
    v_mul_f32 v30, v30, v4
    v_mul_f32 v31, v31, v4
    v_cvt_pk_bf16_f32 v92, v12, v13
    v_cvt_pk_bf16_f32 v93, v14, v15
    v_cvt_pk_bf16_f32 v94, v28, v29
    v_cvt_pk_bf16_f32 v95, v30, v31
    buffer_store_dwordx4 v[92:95], v131, s[20:23], s46 offen offset:0 sc1
    v_mul_f32 v44, v44, v4
    v_mul_f32 v45, v45, v4
    v_mul_f32 v46, v46, v4
    v_mul_f32 v47, v47, v4
    v_mul_f32 v60, v60, v4
    v_mul_f32 v61, v61, v4
    v_mul_f32 v62, v62, v4
    v_mul_f32 v63, v63, v4
    v_cvt_pk_bf16_f32 v96, v44, v45
    v_cvt_pk_bf16_f32 v97, v46, v47
    v_cvt_pk_bf16_f32 v98, v60, v61
    v_cvt_pk_bf16_f32 v99, v62, v63
    buffer_store_dwordx4 v[96:99], v131, s[20:23], s46 offen offset:2048 sc1
    v_mul_f32 v16, v16, v5
    v_mul_f32 v17, v17, v5
    v_mul_f32 v18, v18, v5
    v_mul_f32 v19, v19, v5
    v_mul_f32 v32, v32, v5
    v_mul_f32 v33, v33, v5
    v_mul_f32 v34, v34, v5
    v_mul_f32 v35, v35, v5
    v_cvt_pk_bf16_f32 v100, v16, v17
    v_cvt_pk_bf16_f32 v101, v18, v19
    v_cvt_pk_bf16_f32 v102, v32, v33
    v_cvt_pk_bf16_f32 v103, v34, v35
    buffer_store_dwordx4 v[100:103], v131, s[20:23], s46 offen offset:256 sc1
    v_mul_f32 v48, v48, v5
    v_mul_f32 v49, v49, v5
    v_mul_f32 v50, v50, v5
    v_mul_f32 v51, v51, v5
    v_mul_f32 v64, v64, v5
    v_mul_f32 v65, v65, v5
    v_mul_f32 v66, v66, v5
    v_mul_f32 v67, v67, v5
    v_cvt_pk_bf16_f32 v104, v48, v49
    v_cvt_pk_bf16_f32 v105, v50, v51
    v_cvt_pk_bf16_f32 v106, v64, v65
    v_cvt_pk_bf16_f32 v107, v66, v67
    buffer_store_dwordx4 v[104:107], v131, s[20:23], s46 offen offset:2304 sc1
    v_mul_f32 v20, v20, v6
    v_mul_f32 v21, v21, v6
    v_mul_f32 v22, v22, v6
    v_mul_f32 v23, v23, v6
    v_mul_f32 v36, v36, v6
    v_mul_f32 v37, v37, v6
    v_mul_f32 v38, v38, v6
    v_mul_f32 v39, v39, v6
    v_cvt_pk_bf16_f32 v108, v20, v21
    v_cvt_pk_bf16_f32 v109, v22, v23
    v_cvt_pk_bf16_f32 v110, v36, v37
    v_cvt_pk_bf16_f32 v111, v38, v39
    buffer_store_dwordx4 v[108:111], v131, s[20:23], s47 offen offset:0 sc1
    v_mul_f32 v52, v52, v6
    v_mul_f32 v53, v53, v6
    v_mul_f32 v54, v54, v6
    v_mul_f32 v55, v55, v6
    v_mul_f32 v68, v68, v6
    v_mul_f32 v69, v69, v6
    v_mul_f32 v70, v70, v6
    v_mul_f32 v71, v71, v6
    v_cvt_pk_bf16_f32 v112, v52, v53
    v_cvt_pk_bf16_f32 v113, v54, v55
    v_cvt_pk_bf16_f32 v114, v68, v69
    v_cvt_pk_bf16_f32 v115, v70, v71
    buffer_store_dwordx4 v[112:115], v131, s[20:23], s47 offen offset:2048 sc1
    v_mul_f32 v24, v24, v7
    v_mul_f32 v25, v25, v7
    v_mul_f32 v26, v26, v7
    v_mul_f32 v27, v27, v7
    v_mul_f32 v40, v40, v7
    v_mul_f32 v41, v41, v7
    v_mul_f32 v42, v42, v7
    v_mul_f32 v43, v43, v7
    v_cvt_pk_bf16_f32 v116, v24, v25
    v_cvt_pk_bf16_f32 v117, v26, v27
    v_cvt_pk_bf16_f32 v118, v40, v41
    v_cvt_pk_bf16_f32 v119, v42, v43
    buffer_store_dwordx4 v[116:119], v131, s[20:23], s47 offen offset:256 sc1
    v_mul_f32 v56, v56, v7
    v_mul_f32 v57, v57, v7
    v_mul_f32 v58, v58, v7
    v_mul_f32 v59, v59, v7
    v_mul_f32 v72, v72, v7
    v_mul_f32 v73, v73, v7
    v_mul_f32 v74, v74, v7
    v_mul_f32 v75, v75, v7
    v_cvt_pk_bf16_f32 v120, v56, v57
    v_cvt_pk_bf16_f32 v121, v58, v59
    v_cvt_pk_bf16_f32 v122, v72, v73
    v_cvt_pk_bf16_f32 v123, v74, v75
    buffer_store_dwordx4 v[120:123], v131, s[20:23], s47 offen offset:2304 sc1
epidone_15:
    s_lshl_b32 s44, s27, 1
    s_add_u32 s44, s44, s25
    s_lshl_b32 s44, s44, 13
    s_lshl_b32 s45, s28, 2
    s_add_u32 s45, s45, s26
    s_lshl_b32 s45, s45, 7
    s_add_u32 s44, s44, s45
    s_add_u32 s41, s44, 15204352
    s_nop 1
    v_mov_b32 v52, 0
    v_mov_b32 v53, 0
    v_mov_b32 v54, 0
    v_mov_b32 v55, 0
    v_mov_b32 v56, 0
    v_mov_b32 v57, 0
    v_mov_b32 v58, 0
    v_mov_b32 v59, 0
    v_mov_b32 v60, 0
    v_mov_b32 v61, 0
    v_mov_b32 v62, 0
    v_mov_b32 v63, 0
    v_mov_b32 v64, 0
    v_mov_b32 v65, 0
    v_mov_b32 v66, 0
    v_mov_b32 v67, 0
    v_mov_b32 v68, 0
    v_mov_b32 v72, 0
    v_mov_b32 v69, 0
    v_mov_b32 v73, 0
    v_mov_b32 v70, 0
    v_mov_b32 v74, 0
    v_mov_b32 v71, 0
    v_mov_b32 v75, 0
    s_mov_b32 s45, 49152
    v_lshl_add_u32 v114, v1, 4, s45
    v_lshl_add_u32 v115, v1, 3, s45
    s_mul_i32 s45, s24, 5
    v_lshlrev_b32 v8, 4, v3
    s_lshr_b32 s44, s30, 2
    s_lshl_b32 s46, s29, 1
    s_add_u32 s44, s44, s46
    s_mul_i32 s44, s44, 40960
    s_and_b32 s46, s30, 3
    s_mul_i32 s46, s46, 10240
    s_add_u32 s44, s44, s46
    s_add_u32 s40, s44, 7340032
    s_add_u32 s46, s45, 0
    v_add_u32 v9, s46, v2
    v_lshrrev_b32 v10, 3, v9
    v_lshl_add_u32 v10, v10, 11, v8
    v_and_b32 v11, 3, v9
    v_lshl_add_u32 v10, v11, 9, v10
    v_bfe_u32 v9, v9, 2, 1
    v_lshl_add_u32 v17, v9, 3, v10
    s_add_u32 s46, s45, 2
    v_add_u32 v9, s46, v2
    v_lshrrev_b32 v10, 3, v9
    v_lshl_add_u32 v10, v10, 11, v8
    v_and_b32 v11, 3, v9
    v_lshl_add_u32 v10, v11, 9, v10
    v_bfe_u32 v9, v9, 2, 1
    v_lshl_add_u32 v18, v9, 3, v10
    s_add_u32 s46, s45, 4
    v_mov_b32 v9, s46
    v_lshrrev_b32 v10, 3, v9
    v_lshl_add_u32 v10, v10, 11, v8
    v_and_b32 v11, 3, v9
    v_lshl_add_u32 v10, v11, 9, v10
    v_bfe_u32 v9, v9, 2, 1
    v_lshl_add_u32 v19, v9, 3, v10
    s_setprio 0
    v_mov_b32 v104, 0
    v_mov_b32 v105, 0
    v_mov_b32 v106, 0
    v_mov_b32 v107, 0
    v_mov_b32 v108, 0
    v_mov_b32 v109, 0
    v_mov_b32 v110, 0
    v_mov_b32 v111, 0
    s_mov_b32 s93, 200000
qp_16:
    buffer_load_dwordx2 v[76:77], v17, s[20:23], s40 offen sc1
    buffer_load_dwordx2 v[78:79], v18, s[20:23], s40 offen sc1
    buffer_load_dwordx2 v[112:113], v19, s[20:23], s40 offen sc1
    s_waitcnt vmcnt(0)
    v_max3_u32 v4, v76, v77, v78
    v_max3_u32 v5, v79, v112, v113
    v_max_u32 v4, v4, v5
    v_cmp_eq_u32 vcc, -1, v4
    s_nop 1
    s_cmp_eq_u64 vcc, 0
    s_cbranch_scc1 qpd_17
    s_sub_u32 s93, s93, 1
    s_cbranch_scc1 qpd_17
    s_sleep 4
    s_branch qp_16
qpd_17:
    v_mov_b32 v6, 0
    v_cndmask_b32 v112, v112, v6, s[62:63]
    v_cndmask_b32 v113, v113, v6, s[62:63]
    s_barrier
    ds_read_b128 v[80:83], v114 offset:0
    ds_read_b128 v[84:87], v114 offset:1024
    ds_read2st64_b64 v[88:91], v115 offset0:4 offset1:5
    s_waitcnt lgkmcnt(0)
    v_mfma_f32_32x32x16_bf16 v[20:35], v[80:83], v[76:79], 0
    v_mfma_f32_32x32x16_bf16 v[36:51], v[84:87], v[76:79], 0
    s_cmp_eq_u32 s57, 1
    s_cbranch_scc1 nohst_18
    buffer_store_dwordx4 v[148:151], v131, s[20:23], s42 offen offset:0 sc1
    buffer_store_dwordx4 v[152:155], v131, s[20:23], s42 offen offset:256 sc1
    buffer_store_dwordx4 v[156:159], v131, s[20:23], s43 offen offset:0 sc1
    buffer_store_dwordx4 v[160:163], v131, s[20:23], s43 offen offset:256 sc1
nohst_18:
    s_nop 9
    v_mfma_f32_32x32x8_bf16 v[20:35], v[88:89], v[112:113], v[20:35]
    v_mfma_f32_32x32x8_bf16 v[36:51], v[90:91], v[112:113], v[36:51]
    s_nop 11
    v_max3_f32 v8, v20, v21, v22
    v_max3_f32 v9, v36, v37, v38
    v_max3_f32 v8, v8, v23, v24
    v_max3_f32 v9, v9, v39, v40
    v_max3_f32 v8, v8, v25, v26
    v_max3_f32 v9, v9, v41, v42
    v_max3_f32 v8, v8, v27, v28
    v_max3_f32 v9, v9, v43, v44
    v_max3_f32 v8, v8, v29, v30
    v_max3_f32 v9, v9, v45, v46
    v_max3_f32 v8, v8, v31, v32
    v_max3_f32 v9, v9, v47, v48
    v_max3_f32 v8, v8, v33, v34
    v_max3_f32 v9, v9, v49, v50
    v_max3_f32 v8, v8, v35, v51
    v_max_f32 v8, v8, v9
    v_mov_b32 v16, v8
    s_nop 1
    v_permlane32_swap_b32 v8, v16
    s_nop 1
    v_max_f32 v8, v8, v16
    v_sub_f32 v12, 3267887104, v8
    v_cvt_pk_bf16_f32 v13, v12, v12
    v_and_b32 v14, 0xffff0000, v13
    v_sub_f32 v14, v12, v14
    v_cvt_pk_bf16_f32 v13, v12, v14
    v_and_b32 v15, 0xffff0000, v13
    v_sub_f32 v14, v14, v15
    v_mov_b32 v15, 0
    v_cvt_pk_bf16_f32 v14, v14, v15
    v_cndmask_b32 v112, v112, v13, s[62:63]
    v_cndmask_b32 v113, v113, v14, s[62:63]
    s_nop 1
    v_mfma_f32_32x32x16_bf16 v[20:35], v[80:83], v[76:79], 0
    ds_read_b128 v[80:83], v114 offset:7168
    s_mov_b32 s34, 4
    s_nop 7
    v_mfma_f32_32x32x8_bf16 v[20:35], v[88:89], v[112:113], v[20:35]
    s_nop 9
    s_cmp_eq_u32 s57, 1
    s_cselect_b32 s33, 99, 4
    ds_read2st64_b64 v[92:95], v115 offset0:18 offset1:19
.p2align 6
att_23:
    v_mfma_f32_32x32x16_bf16 v[36:51], v[84:87], v[76:79], 0
    ds_read_b128 v[84:87], v114 offset:8192
    s_waitcnt lgkmcnt(2)
    v_exp_f32 v20, v20
    v_exp_f32 v21, v21
    v_exp_f32 v22, v22
    v_exp_f32 v23, v23
    v_cvt_pk_bf16_f32 v96, v20, v21
    v_mfma_f32_32x32x16_bf16 v[52:67], v[68:71], v[104:107], v[52:67]
    ds_read_b128 v[68:71], v114 offset:3072
    v_exp_f32 v24, v24
    v_exp_f32 v25, v25
    v_cvt_pk_bf16_f32 v97, v22, v23
    v_exp_f32 v26, v26
    v_exp_f32 v27, v27
    v_cvt_pk_bf16_f32 v98, v24, v25
    v_mfma_f32_32x32x8_bf16 v[36:51], v[90:91], v[112:113], v[36:51]
    s_waitcnt lgkmcnt(2)
    v_exp_f32 v28, v28
    v_exp_f32 v29, v29
    v_cvt_pk_bf16_f32 v99, v26, v27
    v_exp_f32 v30, v30
    v_exp_f32 v31, v31
    v_cvt_pk_bf16_f32 v100, v28, v29
    v_mfma_f32_32x32x16_bf16 v[52:67], v[72:75], v[108:111], v[52:67]
    ds_read_b128 v[72:75], v114 offset:4096
    v_exp_f32 v32, v32
    v_exp_f32 v33, v33
    v_cvt_pk_bf16_f32 v101, v30, v31
    v_exp_f32 v34, v34
    v_exp_f32 v35, v35
    v_cvt_pk_bf16_f32 v102, v32, v33
    v_cvt_pk_bf16_f32 v103, v34, v35
    v_mfma_f32_32x32x16_bf16 v[20:35], v[80:83], v[76:79], 0
    s_barrier
    ds_read_b128 v[80:83], v114 offset:14336
    s_waitcnt lgkmcnt(2)
    v_exp_f32 v36, v36
    v_exp_f32 v37, v37
    v_exp_f32 v38, v38
    v_exp_f32 v39, v39
    v_cvt_pk_bf16_f32 v104, v36, v37
    v_mfma_f32_32x32x16_bf16 v[52:67], v[68:71], v[96:99], v[52:67]
    ds_read_b128 v[68:71], v114 offset:5120
    ds_read2st64_b64 v[88:91], v115 offset0:32 offset1:33
    v_exp_f32 v40, v40
    v_exp_f32 v41, v41
    v_cvt_pk_bf16_f32 v105, v38, v39
    v_exp_f32 v42, v42
    v_exp_f32 v43, v43
    v_cvt_pk_bf16_f32 v106, v40, v41
    v_mfma_f32_32x32x8_bf16 v[20:35], v[92:93], v[112:113], v[20:35]
    s_waitcnt lgkmcnt(3)
    v_exp_f32 v44, v44
    v_exp_f32 v45, v45
    v_cvt_pk_bf16_f32 v107, v42, v43
    v_exp_f32 v46, v46
    v_exp_f32 v47, v47
    v_cvt_pk_bf16_f32 v108, v44, v45
    v_mfma_f32_32x32x16_bf16 v[52:67], v[72:75], v[100:103], v[52:67]
    ds_read_b128 v[72:75], v114 offset:6144
    v_exp_f32 v48, v48
    v_exp_f32 v49, v49
    v_cvt_pk_bf16_f32 v109, v46, v47
    v_exp_f32 v50, v50
    v_exp_f32 v51, v51
    v_cvt_pk_bf16_f32 v110, v48, v49
    v_cvt_pk_bf16_f32 v111, v50, v51
    v_mfma_f32_32x32x16_bf16 v[36:51], v[84:87], v[76:79], 0
    ds_read_b128 v[84:87], v114 offset:15360
    s_waitcnt lgkmcnt(2)
    v_exp_f32 v20, v20
    v_exp_f32 v21, v21
    v_exp_f32 v22, v22
    v_exp_f32 v23, v23
    v_cvt_pk_bf16_f32 v96, v20, v21
    v_mfma_f32_32x32x16_bf16 v[52:67], v[68:71], v[104:107], v[52:67]
    ds_read_b128 v[68:71], v114 offset:10240
    v_exp_f32 v24, v24
    v_exp_f32 v25, v25
    v_cvt_pk_bf16_f32 v97, v22, v23
    v_exp_f32 v26, v26
    v_exp_f32 v27, v27
    v_cvt_pk_bf16_f32 v98, v24, v25
    v_mfma_f32_32x32x8_bf16 v[36:51], v[94:95], v[112:113], v[36:51]
    s_waitcnt lgkmcnt(2)
    v_exp_f32 v28, v28
    v_exp_f32 v29, v29
    v_cvt_pk_bf16_f32 v99, v26, v27
    v_exp_f32 v30, v30
    v_exp_f32 v31, v31
    v_cvt_pk_bf16_f32 v100, v28, v29
    v_mfma_f32_32x32x16_bf16 v[52:67], v[72:75], v[108:111], v[52:67]
    ds_read_b128 v[72:75], v114 offset:11264
    v_exp_f32 v32, v32
    v_exp_f32 v33, v33
    v_cvt_pk_bf16_f32 v101, v30, v31
    v_exp_f32 v34, v34
    v_exp_f32 v35, v35
    v_cvt_pk_bf16_f32 v102, v32, v33
    v_cvt_pk_bf16_f32 v103, v34, v35
    v_mfma_f32_32x32x16_bf16 v[20:35], v[80:83], v[76:79], 0
    ds_read_b128 v[80:83], v114 offset:21504
    s_waitcnt lgkmcnt(2)
    v_exp_f32 v36, v36
    v_exp_f32 v37, v37
    v_exp_f32 v38, v38
    v_exp_f32 v39, v39
    v_cvt_pk_bf16_f32 v104, v36, v37
    v_mfma_f32_32x32x16_bf16 v[52:67], v[68:71], v[96:99], v[52:67]
    ds_read_b128 v[68:71], v114 offset:12288
    ds_read2st64_b64 v[92:95], v115 offset0:46 offset1:47
    v_exp_f32 v40, v40
    v_exp_f32 v41, v41
    v_cvt_pk_bf16_f32 v105, v38, v39
    v_exp_f32 v42, v42
    v_exp_f32 v43, v43
    v_cvt_pk_bf16_f32 v106, v40, v41
    v_mfma_f32_32x32x8_bf16 v[20:35], v[88:89], v[112:113], v[20:35]
    s_waitcnt lgkmcnt(3)
    v_exp_f32 v44, v44
    v_exp_f32 v45, v45
    v_cvt_pk_bf16_f32 v107, v42, v43
    v_exp_f32 v46, v46
    v_exp_f32 v47, v47
    v_cvt_pk_bf16_f32 v108, v44, v45
    v_mfma_f32_32x32x16_bf16 v[52:67], v[72:75], v[100:103], v[52:67]
    ds_read_b128 v[72:75], v114 offset:13312
    v_exp_f32 v48, v48
    v_exp_f32 v49, v49
    v_cvt_pk_bf16_f32 v109, v46, v47
    v_exp_f32 v50, v50
    v_exp_f32 v51, v51
    v_cvt_pk_bf16_f32 v110, v48, v49
    v_cvt_pk_bf16_f32 v111, v50, v51
    v_mfma_f32_32x32x16_bf16 v[36:51], v[84:87], v[76:79], 0
    ds_read_b128 v[84:87], v114 offset:22528
    s_waitcnt lgkmcnt(2)
    v_exp_f32 v20, v20
    v_exp_f32 v21, v21
    v_exp_f32 v22, v22
    v_exp_f32 v23, v23
    v_cvt_pk_bf16_f32 v96, v20, v21
    v_mfma_f32_32x32x16_bf16 v[52:67], v[68:71], v[104:107], v[52:67]
    ds_read_b128 v[68:71], v114 offset:17408
    v_exp_f32 v24, v24
    v_exp_f32 v25, v25
    v_cvt_pk_bf16_f32 v97, v22, v23
    v_exp_f32 v26, v26
    v_exp_f32 v27, v27
    v_cvt_pk_bf16_f32 v98, v24, v25
    v_mfma_f32_32x32x8_bf16 v[36:51], v[90:91], v[112:113], v[36:51]
    s_waitcnt lgkmcnt(2)
    v_exp_f32 v28, v28
    v_exp_f32 v29, v29
    v_cvt_pk_bf16_f32 v99, v26, v27
    v_exp_f32 v30, v30
    v_exp_f32 v31, v31
    v_cvt_pk_bf16_f32 v100, v28, v29
    v_mfma_f32_32x32x16_bf16 v[52:67], v[72:75], v[108:111], v[52:67]
    ds_read_b128 v[72:75], v114 offset:18432
    v_exp_f32 v32, v32
    v_exp_f32 v33, v33
    v_cvt_pk_bf16_f32 v101, v30, v31
    v_exp_f32 v34, v34
    v_exp_f32 v35, v35
    v_cvt_pk_bf16_f32 v102, v32, v33
    v_cvt_pk_bf16_f32 v103, v34, v35
    v_mfma_f32_32x32x16_bf16 v[20:35], v[80:83], v[76:79], 0
    s_barrier
    ds_read_b128 v[80:83], v114 offset:28672
    s_waitcnt lgkmcnt(2)
    v_exp_f32 v36, v36
    v_exp_f32 v37, v37
    v_exp_f32 v38, v38
    v_exp_f32 v39, v39
    v_cvt_pk_bf16_f32 v104, v36, v37
    v_mfma_f32_32x32x16_bf16 v[52:67], v[68:71], v[96:99], v[52:67]
    ds_read_b128 v[68:71], v114 offset:19456
    ds_read2st64_b64 v[88:91], v115 offset0:60 offset1:61
    v_exp_f32 v40, v40
    v_exp_f32 v41, v41
    v_cvt_pk_bf16_f32 v105, v38, v39
    v_exp_f32 v42, v42
    v_exp_f32 v43, v43
    v_cvt_pk_bf16_f32 v106, v40, v41
    v_mfma_f32_32x32x8_bf16 v[20:35], v[92:93], v[112:113], v[20:35]
    s_waitcnt lgkmcnt(3)
    v_exp_f32 v44, v44
    v_exp_f32 v45, v45
    v_cvt_pk_bf16_f32 v107, v42, v43
    v_exp_f32 v46, v46
    v_exp_f32 v47, v47
    v_cvt_pk_bf16_f32 v108, v44, v45
    v_mfma_f32_32x32x16_bf16 v[52:67], v[72:75], v[100:103], v[52:67]
    ds_read_b128 v[72:75], v114 offset:20480
    v_exp_f32 v48, v48
    v_exp_f32 v49, v49
    v_cvt_pk_bf16_f32 v109, v46, v47
    v_exp_f32 v50, v50
    v_exp_f32 v51, v51
    v_cvt_pk_bf16_f32 v110, v48, v49
    v_cvt_pk_bf16_f32 v111, v50, v51
    v_mfma_f32_32x32x16_bf16 v[36:51], v[84:87], v[76:79], 0
    ds_read_b128 v[84:87], v114 offset:29696
    s_waitcnt lgkmcnt(2)
    v_exp_f32 v20, v20
    v_exp_f32 v21, v21
    v_exp_f32 v22, v22
    v_exp_f32 v23, v23
    v_cvt_pk_bf16_f32 v96, v20, v21
    v_mfma_f32_32x32x16_bf16 v[52:67], v[68:71], v[104:107], v[52:67]
    ds_read_b128 v[68:71], v114 offset:24576
    v_exp_f32 v24, v24
    v_exp_f32 v25, v25
    v_cvt_pk_bf16_f32 v97, v22, v23
    v_exp_f32 v26, v26
    v_exp_f32 v27, v27
    v_cvt_pk_bf16_f32 v98, v24, v25
    v_mfma_f32_32x32x8_bf16 v[36:51], v[94:95], v[112:113], v[36:51]
    s_waitcnt lgkmcnt(2)
    v_exp_f32 v28, v28
    v_exp_f32 v29, v29
    v_cvt_pk_bf16_f32 v99, v26, v27
    v_exp_f32 v30, v30
    v_exp_f32 v31, v31
    v_cvt_pk_bf16_f32 v100, v28, v29
    v_mfma_f32_32x32x16_bf16 v[52:67], v[72:75], v[108:111], v[52:67]
    ds_read_b128 v[72:75], v114 offset:25600
    s_cmp_eq_u32 s34, 4
    s_cbranch_scc1 hflag_19
hback_20:
    v_exp_f32 v32, v32
    v_exp_f32 v33, v33
    v_cvt_pk_bf16_f32 v101, v30, v31
    v_exp_f32 v34, v34
    v_exp_f32 v35, v35
    v_cvt_pk_bf16_f32 v102, v32, v33
    v_cvt_pk_bf16_f32 v103, v34, v35
    v_mfma_f32_32x32x16_bf16 v[20:35], v[80:83], v[76:79], 0
    ds_read_b128 v[80:83], v114 offset:35840
    s_waitcnt lgkmcnt(2)
    v_exp_f32 v36, v36
    v_exp_f32 v37, v37
    v_exp_f32 v38, v38
    v_exp_f32 v39, v39
    v_cvt_pk_bf16_f32 v104, v36, v37
    v_mfma_f32_32x32x16_bf16 v[52:67], v[68:71], v[96:99], v[52:67]
    ds_read_b128 v[68:71], v114 offset:26624
    ds_read2st64_b64 v[92:95], v115 offset0:74 offset1:75
    v_exp_f32 v40, v40
    v_exp_f32 v41, v41
    v_cvt_pk_bf16_f32 v105, v38, v39
    v_exp_f32 v42, v42
    v_exp_f32 v43, v43
    v_cvt_pk_bf16_f32 v106, v40, v41
    v_mfma_f32_32x32x8_bf16 v[20:35], v[88:89], v[112:113], v[20:35]
    s_waitcnt lgkmcnt(3)
    v_exp_f32 v44, v44
    v_exp_f32 v45, v45
    v_cvt_pk_bf16_f32 v107, v42, v43
    v_exp_f32 v46, v46
    v_exp_f32 v47, v47
    v_cvt_pk_bf16_f32 v108, v44, v45
    v_mfma_f32_32x32x16_bf16 v[52:67], v[72:75], v[100:103], v[52:67]
    ds_read_b128 v[72:75], v114 offset:27648
    v_exp_f32 v48, v48
    v_exp_f32 v49, v49
    v_cvt_pk_bf16_f32 v109, v46, v47
    v_exp_f32 v50, v50
    v_exp_f32 v51, v51
    v_cvt_pk_bf16_f32 v110, v48, v49
    v_cvt_pk_bf16_f32 v111, v50, v51
    v_mfma_f32_32x32x16_bf16 v[36:51], v[84:87], v[76:79], 0
    ds_read_b128 v[84:87], v114 offset:36864
    s_waitcnt lgkmcnt(2)
    v_exp_f32 v20, v20
    v_exp_f32 v21, v21
    v_exp_f32 v22, v22
    v_exp_f32 v23, v23
    v_cvt_pk_bf16_f32 v96, v20, v21
    v_mfma_f32_32x32x16_bf16 v[52:67], v[68:71], v[104:107], v[52:67]
    ds_read_b128 v[68:71], v114 offset:31744
    v_exp_f32 v24, v24
    v_exp_f32 v25, v25
    v_cvt_pk_bf16_f32 v97, v22, v23
    v_exp_f32 v26, v26
    v_exp_f32 v27, v27
    v_cvt_pk_bf16_f32 v98, v24, v25
    v_mfma_f32_32x32x8_bf16 v[36:51], v[90:91], v[112:113], v[36:51]
    s_waitcnt lgkmcnt(2)
    v_exp_f32 v28, v28
    v_exp_f32 v29, v29
    v_cvt_pk_bf16_f32 v99, v26, v27
    v_exp_f32 v30, v30
    v_exp_f32 v31, v31
    v_cvt_pk_bf16_f32 v100, v28, v29
    v_mfma_f32_32x32x16_bf16 v[52:67], v[72:75], v[108:111], v[52:67]
    ds_read_b128 v[72:75], v114 offset:32768
    v_exp_f32 v32, v32
    v_exp_f32 v33, v33
    v_cvt_pk_bf16_f32 v101, v30, v31
    v_exp_f32 v34, v34
    v_exp_f32 v35, v35
    v_cvt_pk_bf16_f32 v102, v32, v33
    v_cvt_pk_bf16_f32 v103, v34, v35
    v_mfma_f32_32x32x16_bf16 v[20:35], v[80:83], v[76:79], 0
    s_barrier
    ds_read_b128 v[80:83], v114 offset:43008
    s_waitcnt lgkmcnt(2)
    v_exp_f32 v36, v36
    v_exp_f32 v37, v37
    v_exp_f32 v38, v38
    v_exp_f32 v39, v39
    v_cvt_pk_bf16_f32 v104, v36, v37
    v_mfma_f32_32x32x16_bf16 v[52:67], v[68:71], v[96:99], v[52:67]
    ds_read_b128 v[68:71], v114 offset:33792
    ds_read2st64_b64 v[88:91], v115 offset0:88 offset1:89
    v_exp_f32 v40, v40
    v_exp_f32 v41, v41
    v_cvt_pk_bf16_f32 v105, v38, v39
    v_exp_f32 v42, v42
    v_exp_f32 v43, v43
    v_cvt_pk_bf16_f32 v106, v40, v41
    v_mfma_f32_32x32x8_bf16 v[20:35], v[92:93], v[112:113], v[20:35]
    s_waitcnt lgkmcnt(3)
    v_exp_f32 v44, v44
    v_exp_f32 v45, v45
    v_cvt_pk_bf16_f32 v107, v42, v43
    v_exp_f32 v46, v46
    v_exp_f32 v47, v47
    v_cvt_pk_bf16_f32 v108, v44, v45
    v_mfma_f32_32x32x16_bf16 v[52:67], v[72:75], v[100:103], v[52:67]
    ds_read_b128 v[72:75], v114 offset:34816
    v_exp_f32 v48, v48
    v_exp_f32 v49, v49
    v_cvt_pk_bf16_f32 v109, v46, v47
    v_exp_f32 v50, v50
    v_exp_f32 v51, v51
    v_cvt_pk_bf16_f32 v110, v48, v49
    v_cvt_pk_bf16_f32 v111, v50, v51
    v_mfma_f32_32x32x16_bf16 v[36:51], v[84:87], v[76:79], 0
    ds_read_b128 v[84:87], v114 offset:44032
    s_waitcnt lgkmcnt(2)
    v_exp_f32 v20, v20
    v_exp_f32 v21, v21
    v_exp_f32 v22, v22
    v_exp_f32 v23, v23
    v_cvt_pk_bf16_f32 v96, v20, v21
    v_mfma_f32_32x32x16_bf16 v[52:67], v[68:71], v[104:107], v[52:67]
    ds_read_b128 v[68:71], v114 offset:38912
    v_exp_f32 v24, v24
    v_exp_f32 v25, v25
    v_cvt_pk_bf16_f32 v97, v22, v23
    v_exp_f32 v26, v26
    v_exp_f32 v27, v27
    v_cvt_pk_bf16_f32 v98, v24, v25
    v_mfma_f32_32x32x8_bf16 v[36:51], v[94:95], v[112:113], v[36:51]
    s_waitcnt lgkmcnt(2)
    v_exp_f32 v28, v28
    v_exp_f32 v29, v29
    v_cvt_pk_bf16_f32 v99, v26, v27
    v_exp_f32 v30, v30
    v_exp_f32 v31, v31
    v_cvt_pk_bf16_f32 v100, v28, v29
    v_mfma_f32_32x32x16_bf16 v[52:67], v[72:75], v[108:111], v[52:67]
    ds_read_b128 v[72:75], v114 offset:39936
    v_exp_f32 v32, v32
    v_exp_f32 v33, v33
    v_cvt_pk_bf16_f32 v101, v30, v31
    v_exp_f32 v34, v34
    v_exp_f32 v35, v35
    v_cvt_pk_bf16_f32 v102, v32, v33
    v_cvt_pk_bf16_f32 v103, v34, v35
    v_mfma_f32_32x32x16_bf16 v[20:35], v[80:83], v[76:79], 0
    ds_read_b128 v[80:83], v114 offset:50176
    s_waitcnt lgkmcnt(2)
    v_exp_f32 v36, v36
    v_exp_f32 v37, v37
    v_exp_f32 v38, v38
    v_exp_f32 v39, v39
    v_cvt_pk_bf16_f32 v104, v36, v37
    v_mfma_f32_32x32x16_bf16 v[52:67], v[68:71], v[96:99], v[52:67]
    ds_read_b128 v[68:71], v114 offset:40960
    ds_read2st64_b64 v[92:95], v115 offset0:102 offset1:103
    v_exp_f32 v40, v40
    v_exp_f32 v41, v41
    v_cvt_pk_bf16_f32 v105, v38, v39
    v_exp_f32 v42, v42
    v_exp_f32 v43, v43
    v_cvt_pk_bf16_f32 v106, v40, v41
    v_mfma_f32_32x32x8_bf16 v[20:35], v[88:89], v[112:113], v[20:35]
    s_waitcnt lgkmcnt(3)
    v_exp_f32 v44, v44
    v_exp_f32 v45, v45
    v_cvt_pk_bf16_f32 v107, v42, v43
    v_exp_f32 v46, v46
    v_exp_f32 v47, v47
    v_cvt_pk_bf16_f32 v108, v44, v45
    v_mfma_f32_32x32x16_bf16 v[52:67], v[72:75], v[100:103], v[52:67]
    ds_read_b128 v[72:75], v114 offset:41984
    v_exp_f32 v48, v48
    v_exp_f32 v49, v49
    v_cvt_pk_bf16_f32 v109, v46, v47
    v_exp_f32 v50, v50
    v_exp_f32 v51, v51
    v_cvt_pk_bf16_f32 v110, v48, v49
    v_cvt_pk_bf16_f32 v111, v50, v51
    v_mfma_f32_32x32x16_bf16 v[36:51], v[84:87], v[76:79], 0
    ds_read_b128 v[84:87], v114 offset:51200
    s_waitcnt lgkmcnt(2)
    v_exp_f32 v20, v20
    v_exp_f32 v21, v21
    v_exp_f32 v22, v22
    v_exp_f32 v23, v23
    v_cvt_pk_bf16_f32 v96, v20, v21
    v_mfma_f32_32x32x16_bf16 v[52:67], v[68:71], v[104:107], v[52:67]
    ds_read_b128 v[68:71], v114 offset:46080
    v_exp_f32 v24, v24
    v_exp_f32 v25, v25
    v_cvt_pk_bf16_f32 v97, v22, v23
    v_exp_f32 v26, v26
    v_exp_f32 v27, v27
    v_cvt_pk_bf16_f32 v98, v24, v25
    v_mfma_f32_32x32x8_bf16 v[36:51], v[90:91], v[112:113], v[36:51]
    s_waitcnt lgkmcnt(2)
    v_exp_f32 v28, v28
    v_exp_f32 v29, v29
    v_cvt_pk_bf16_f32 v99, v26, v27
    v_exp_f32 v30, v30
    v_exp_f32 v31, v31
    v_cvt_pk_bf16_f32 v100, v28, v29
    v_mfma_f32_32x32x16_bf16 v[52:67], v[72:75], v[108:111], v[52:67]
    ds_read_b128 v[72:75], v114 offset:47104
    v_exp_f32 v32, v32
    v_exp_f32 v33, v33
    v_cvt_pk_bf16_f32 v101, v30, v31
    v_exp_f32 v34, v34
    v_exp_f32 v35, v35
    v_cvt_pk_bf16_f32 v102, v32, v33
    v_cvt_pk_bf16_f32 v103, v34, v35
    v_mfma_f32_32x32x16_bf16 v[20:35], v[80:83], v[76:79], 0
    s_barrier
    ds_read_b128 v[80:83], v114 offset:0
    s_waitcnt lgkmcnt(2)
    v_exp_f32 v36, v36
    v_exp_f32 v37, v37
    v_exp_f32 v38, v38
    v_exp_f32 v39, v39
    v_cvt_pk_bf16_f32 v104, v36, v37
    v_mfma_f32_32x32x16_bf16 v[52:67], v[68:71], v[96:99], v[52:67]
    ds_read_b128 v[68:71], v114 offset:48128
    ds_read2st64_b64 v[88:91], v115 offset0:4 offset1:5
    v_exp_f32 v40, v40
    v_exp_f32 v41, v41
    v_cvt_pk_bf16_f32 v105, v38, v39
    v_exp_f32 v42, v42
    v_exp_f32 v43, v43
    v_cvt_pk_bf16_f32 v106, v40, v41
    v_mfma_f32_32x32x8_bf16 v[20:35], v[92:93], v[112:113], v[20:35]
    s_waitcnt lgkmcnt(3)
    v_exp_f32 v44, v44
    v_exp_f32 v45, v45
    v_cvt_pk_bf16_f32 v107, v42, v43
    v_exp_f32 v46, v46
    v_exp_f32 v47, v47
    v_cvt_pk_bf16_f32 v108, v44, v45
    v_mfma_f32_32x32x16_bf16 v[52:67], v[72:75], v[100:103], v[52:67]
    ds_read_b128 v[72:75], v114 offset:49152
    v_exp_f32 v48, v48
    v_exp_f32 v49, v49
    v_cvt_pk_bf16_f32 v109, v46, v47
    v_exp_f32 v50, v50
    v_exp_f32 v51, v51
    v_cvt_pk_bf16_f32 v110, v48, v49
    v_cvt_pk_bf16_f32 v111, v50, v51
    v_mfma_f32_32x32x16_bf16 v[36:51], v[84:87], v[76:79], 0
    ds_read_b128 v[84:87], v114 offset:1024
    s_waitcnt lgkmcnt(2)
    v_exp_f32 v20, v20
    v_exp_f32 v21, v21
    v_exp_f32 v22, v22
    v_exp_f32 v23, v23
    v_cvt_pk_bf16_f32 v96, v20, v21
    v_mfma_f32_32x32x16_bf16 v[52:67], v[68:71], v[104:107], v[52:67]
    ds_read_b128 v[68:71], v114 offset:53248
    v_exp_f32 v24, v24
    v_exp_f32 v25, v25
    v_cvt_pk_bf16_f32 v97, v22, v23
    v_exp_f32 v26, v26
    v_exp_f32 v27, v27
    v_cvt_pk_bf16_f32 v98, v24, v25
    v_mfma_f32_32x32x8_bf16 v[36:51], v[94:95], v[112:113], v[36:51]
    s_waitcnt lgkmcnt(2)
    v_exp_f32 v28, v28
    v_exp_f32 v29, v29
    v_cvt_pk_bf16_f32 v99, v26, v27
    v_exp_f32 v30, v30
    v_exp_f32 v31, v31
    v_cvt_pk_bf16_f32 v100, v28, v29
    v_mfma_f32_32x32x16_bf16 v[52:67], v[72:75], v[108:111], v[52:67]
    ds_read_b128 v[72:75], v114 offset:54272
    v_exp_f32 v32, v32
    v_exp_f32 v33, v33
    v_cvt_pk_bf16_f32 v101, v30, v31
    v_exp_f32 v34, v34
    v_exp_f32 v35, v35
    v_cvt_pk_bf16_f32 v102, v32, v33
    v_cvt_pk_bf16_f32 v103, v34, v35
    v_mfma_f32_32x32x16_bf16 v[20:35], v[80:83], v[76:79], 0
    ds_read_b128 v[80:83], v114 offset:7168
    s_waitcnt lgkmcnt(2)
    v_exp_f32 v36, v36
    v_exp_f32 v37, v37
    v_exp_f32 v38, v38
    v_exp_f32 v39, v39
    v_cvt_pk_bf16_f32 v104, v36, v37
    v_mfma_f32_32x32x16_bf16 v[52:67], v[68:71], v[96:99], v[52:67]
    ds_read_b128 v[68:71], v114 offset:55296
    ds_read2st64_b64 v[92:95], v115 offset0:18 offset1:19
    v_exp_f32 v40, v40
    v_exp_f32 v41, v41
    v_cvt_pk_bf16_f32 v105, v38, v39
    v_exp_f32 v42, v42
    v_exp_f32 v43, v43
    v_cvt_pk_bf16_f32 v106, v40, v41
    v_mfma_f32_32x32x8_bf16 v[20:35], v[88:89], v[112:113], v[20:35]
    s_waitcnt lgkmcnt(3)
    v_exp_f32 v44, v44
    v_exp_f32 v45, v45
    v_cvt_pk_bf16_f32 v107, v42, v43
    v_exp_f32 v46, v46
    v_exp_f32 v47, v47
    v_cvt_pk_bf16_f32 v108, v44, v45
    v_mfma_f32_32x32x16_bf16 v[52:67], v[72:75], v[100:103], v[52:67]
    ds_read_b128 v[72:75], v114 offset:56320
    s_sub_u32 s34, s34, 1
    v_exp_f32 v48, v48
    v_exp_f32 v49, v49
    v_cvt_pk_bf16_f32 v109, v46, v47
    v_exp_f32 v50, v50
    v_exp_f32 v51, v51
    v_cvt_pk_bf16_f32 v110, v48, v49
    v_cvt_pk_bf16_f32 v111, v50, v51
    s_cmp_lg_u32 s34, 0
    s_cbranch_scc1 att_23
    s_waitcnt lgkmcnt(0)
    v_mfma_f32_32x32x16_bf16 v[52:67], v[68:71], v[104:107], v[52:67]
    v_mfma_f32_32x32x16_bf16 v[52:67], v[72:75], v[108:111], v[52:67]
    v_lshlrev_b32 v6, 4, v1
    v_lshlrev_b32 v7, 3, v1
    v_mov_b32 v13, 0x7f000000
    v_cndmask_b32 v7, v7, v13, s[62:63]
    v_lshlrev_b32 v8, 3, v3
    v_lshl_add_u32 v8, v2, 9, v8
    v_mov_b32 v9, 160928
    ds_read_b32 v9, v9
    s_nop 4
    s_mov_b32 s44, 2113929216
    s_mov_b32 s45, 201326592
    v_add_f32 v4, |v52|, |v53|
    v_add_f32 v5, |v54|, |v55|
    v_add_f32 v4, v4, |v56|
    v_add_f32 v5, v5, |v57|
    v_add_f32 v4, v4, |v58|
    v_add_f32 v5, v5, |v59|
    v_add_f32 v4, v4, |v60|
    v_add_f32 v5, v5, |v61|
    v_add_f32 v4, v4, |v62|
    v_add_f32 v5, v5, |v63|
    v_add_f32 v4, v4, v5
    v_add_f32 v5, v4, v64
    s_waitcnt lgkmcnt(0)
    v_readfirstlane_b32 s38, v9
    v_cmp_le_f32 s[46:47], s45, v4
    v_cmp_gt_f32 s[48:49], s44, v5
    s_nop 1
    s_and_b64 s[46:47], s[46:47], s[48:49]
    s_cmp_eq_u64 s[46:47], -1
    s_cbranch_scc0 fb_24
aout_25:
    v_rcp_f32 v4, v64
    s_nop 0
    v_mul_f32 v52, v52, v4
    v_mul_f32 v53, v53, v4
    v_mul_f32 v54, v54, v4
    v_mul_f32 v55, v55, v4
    v_mul_f32 v56, v56, v4
    v_mul_f32 v57, v57, v4
    v_mul_f32 v58, v58, v4
    v_mul_f32 v59, v59, v4
    v_mul_f32 v60, v60, v4
    v_mul_f32 v61, v61, v4
    v_mul_f32 v62, v62, v4
    v_mul_f32 v63, v63, v4
    v_cvt_pk_bf16_f32 v96, v52, v53
    v_cvt_pk_bf16_f32 v97, v54, v55
    v_cvt_pk_bf16_f32 v98, v56, v57
    v_cvt_pk_bf16_f32 v99, v58, v59
    v_cvt_pk_bf16_f32 v100, v60, v61
    v_cvt_pk_bf16_f32 v101, v62, v63
    s_cmp_eq_u32 s38, s98
    s_cbranch_scc1 oplain_26
    buffer_store_dwordx4 v[96:99], v6, s[20:23], s36 offen sc1
    buffer_store_dwordx2 v[100:101], v7, s[20:23], s37 offen sc1
    s_branch ostored_27
oplain_26:
    buffer_store_dwordx4 v[96:99], v6, s[20:23], s36 offen
    buffer_store_dwordx2 v[100:101], v7, s[20:23], s37 offen
ostored_27:
    s_lshr_b32 s57, s30, 1
    s_and_b32 s58, s30, 1
    s_lshl_b32 s44, s29, 1
    s_add_u32 s59, s44, s58
    s_xor_b32 s60, s59, 1
    s_mul_i32 s44, s57, 320
    s_lshl_b32 s45, s58, 7
    s_add_u32 s61, s44, s45
    s_cmp_eq_u32 s25, 1
    s_cselect_b32 s44, s60, s59
    s_mul_i32 s44, s44, 40960
    s_add_u32 s44, s44, 11534336
    s_lshl_b32 s45, s26, 13
    s_add_u32 s38, s44, s45
    s_add_u32 s38, s38, 3072
    s_add_u32 s39, s38, 4096
    s_lshl_b32 s45, s26, 11
    s_add_u32 s40, s44, s45
    s_add_u32 s40, s40, 32768
    s_mul_i32 s44, s26, 14336
    s_lshl_b32 s45, s25, 10
    s_add_u32 s44, s44, s45
    s_add_u32 s44, s44, 49152
    v_add_u32 v9, s44, v6
    s_barrier
    s_mov_b32 s93, 200000
cop_28:
    buffer_load_dwordx4 v[120:123], v6, s[20:23], s38 offen offset:0 sc1
    buffer_load_dwordx4 v[124:127], v6, s[20:23], s38 offen offset:1024 sc1
    buffer_load_dwordx4 v[128:131], v6, s[20:23], s38 offen offset:2048 sc1
    buffer_load_dwordx4 v[132:135], v6, s[20:23], s38 offen offset:3072 sc1
    buffer_load_dwordx4 v[136:139], v6, s[20:23], s39 offen offset:0 sc1
    buffer_load_dwordx2 v[140:141], v8, s[20:23], s40 offen offset:0 sc1
    buffer_load_dwordx2 v[142:143], v8, s[20:23], s40 offen offset:256 sc1
    buffer_load_dwordx2 v[144:145], v8, s[20:23], s40 offen offset:1024 sc1
    buffer_load_dwordx2 v[146:147], v8, s[20:23], s40 offen offset:1280 sc1
    s_waitcnt vmcnt(0)
    v_max3_u32 v4, v120, v121, v122
    v_max3_u32 v4, v4, v123, v124
    v_max3_u32 v4, v4, v125, v126
    v_max3_u32 v4, v4, v127, v128
    v_max3_u32 v4, v4, v129, v130
    v_max3_u32 v4, v4, v131, v132
    v_max3_u32 v4, v4, v133, v134
    v_max3_u32 v4, v4, v135, v136
    v_max3_u32 v4, v4, v137, v138
    v_max3_u32 v4, v4, v139, v140
    v_max3_u32 v4, v4, v141, v142
    v_max3_u32 v4, v4, v143, v144
    v_max3_u32 v4, v4, v145, v146
    v_max_u32 v4, v4, v147
    v_cmp_eq_u32 vcc, -1, v4
    s_nop 1
    s_cmp_eq_u64 vcc, 0
    s_cbranch_scc1 copd_29
    s_sub_u32 s93, s93, 1
    s_cbranch_scc1 copd_29
    s_sleep 3
    s_branch cop_28
copd_29:
    ds_write_b128 v9, v[120:123] offset:0
    ds_write_b128 v9, v[124:127] offset:2048
    ds_write_b128 v9, v[128:131] offset:4096
    ds_write_b128 v9, v[132:135] offset:6144
    ds_write_b128 v9, v[136:139] offset:8192
    ds_write_b128 v9, v[140:143] offset:10240
    ds_write_b128 v9, v[144:147] offset:12288
    s_cmp_ge_u32 s24, 10
    s_cbranch_scc1 g2o_30
    s_lshr_b32 s45, s24, 1
    s_and_b32 s46, s24, 1
    s_lshl_b32 s46, s46, 4
    v_lshrrev_b32 v20, 2, v1
    v_add_u32 v20, s46, v20
    v_and_b32 v21, 3, v1
    s_and_b32 s47, s45, 1
    s_cmp_eq_u32 s47, 1
    s_cselect_b32 s47, s60, s59
    s_mul_i32 s47, s47, 40960
    s_lshr_b32 s48, s45, 1
    s_add_u32 s49, s48, s58
    s_lshl_b32 s49, s49, 6
    s_lshl_b32 s50, s58, 7
    s_sub_u32 s50, 128, s50
    s_cmp_eq_u32 s48, 2
    s_cselect_b32 s49, s50, s49
    s_add_u32 s47, s47, s49
    s_add_u32 s31, s47, s61
    v_mul_u32_u24 v26, 1280, v20
    v_lshl_add_u32 v26, v21, 4, v26
    buffer_load_dwordx4 v[22:25], v26, s[8:11], s31 offen
    v_lshlrev_b32 v21, 1, v21
    v_and_b32 v27, 7, v20
    v_xor_b32 v21, v21, v27
    v_lshlrev_b32 v20, 7, v20
    v_lshl_add_u32 v20, v21, 4, v20
    s_lshl_b32 s47, s45, 12
    v_add_u32 v20, s47, v20
    v_xor_b32 v21, 16, v20
g2o_30:
    s_waitcnt lgkmcnt(0)
    s_barrier
    s_barrier
    s_cmp_ge_u32 s24, 10
    s_cbranch_scc1 g2o_31
    ds_read_b128 v[28:31], v20 offset:0
    ds_read_b128 v[32:35], v21 offset:0
    ds_read_b128 v[36:39], v20 offset:21504
    ds_read_b128 v[40:43], v21 offset:21504
    v_add_u32 v20, 106496, v20
    v_add_u32 v21, 106496, v21
    ds_read_b128 v[44:47], v20 offset:0
    ds_read_b128 v[48:51], v21 offset:0
    ds_read_b128 v[52:55], v20 offset:21504
    ds_read_b128 v[56:59], v21 offset:21504
    s_waitcnt vmcnt(0)
    v_lshlrev_b32 v60, 16, v22
    v_and_b32 v61, 0xffff0000, v22
    v_lshlrev_b32 v62, 16, v23
    v_and_b32 v63, 0xffff0000, v23
    v_lshlrev_b32 v64, 16, v24
    v_and_b32 v65, 0xffff0000, v24
    v_lshlrev_b32 v66, 16, v25
    v_and_b32 v67, 0xffff0000, v25
    s_waitcnt lgkmcnt(4)
    v_pk_add_f32 v[28:29], v[28:29], v[36:37]
    v_pk_add_f32 v[30:31], v[30:31], v[38:39]
    v_pk_add_f32 v[32:33], v[32:33], v[40:41]
    v_pk_add_f32 v[34:35], v[34:35], v[42:43]
    v_pk_add_f32 v[28:29], v[28:29], v[60:61]
    v_pk_add_f32 v[30:31], v[30:31], v[62:63]
    v_pk_add_f32 v[32:33], v[32:33], v[64:65]
    v_pk_add_f32 v[34:35], v[34:35], v[66:67]
    s_waitcnt lgkmcnt(0)
    v_pk_add_f32 v[44:45], v[44:45], v[52:53]
    v_pk_add_f32 v[46:47], v[46:47], v[54:55]
    v_pk_add_f32 v[48:49], v[48:49], v[56:57]
    v_pk_add_f32 v[50:51], v[50:51], v[58:59]
    v_pk_add_f32 v[28:29], v[28:29], v[44:45]
    v_pk_add_f32 v[30:31], v[30:31], v[46:47]
    v_pk_add_f32 v[32:33], v[32:33], v[48:49]
    v_pk_add_f32 v[34:35], v[34:35], v[50:51]
    v_cvt_pk_bf16_f32 v36, v28, v29
    v_cvt_pk_bf16_f32 v37, v30, v31
    v_cvt_pk_bf16_f32 v38, v32, v33
    v_cvt_pk_bf16_f32 v39, v34, v35
    buffer_store_dwordx4 v[36:39], v26, s[64:67], s31 offen
g2o_31:
    s_branch end_1
hflag_19:
    s_waitcnt vmcnt(0)
    v_mov_b32 v6, s98
    v_mov_b32 v7, s99
    s_mov_b64 exec, 1
    buffer_store_dwordx2 v[6:7], off, s[20:23], s41 sc1
    s_mov_b64 exec, -1
    s_branch hback_20
fb_24:
    v_lshlrev_b32 v17, 4, v1
    v_lshlrev_b32 v11, 3, v1
    v_mov_b32 v18, 0
    v_mov_b32 v19, 0xff800000
    v_cndmask_b32 v112, v112, v18, s[62:63]
    v_cndmask_b32 v113, v113, v18, s[62:63]
    s_mov_b32 s77, 10485760
    s_mov_b32 s34, 32
fb1_32:
    buffer_load_dwordx4 v[80:83], v17, s[20:23], s77 offen sc1
    buffer_load_dwordx4 v[84:87], v17, s[20:23], s77 offen offset:1024 sc1
    buffer_load_dwordx2 v[88:89], v11, s[20:23], s77 offen offset:2048 sc1
    buffer_load_dwordx2 v[90:91], v11, s[20:23], s77 offen offset:2560 sc1
    s_waitcnt vmcnt(0)
    v_mfma_f32_32x32x16_bf16 v[20:35], v[80:83], v[76:79], 0
    v_mfma_f32_32x32x16_bf16 v[36:51], v[84:87], v[76:79], 0
    s_nop 9
    v_mfma_f32_32x32x8_bf16 v[20:35], v[88:89], v[112:113], v[20:35]
    v_mfma_f32_32x32x8_bf16 v[36:51], v[90:91], v[112:113], v[36:51]
    s_nop 15
    v_max3_f32 v19, v19, v20, v21
    v_max3_f32 v19, v19, v22, v23
    v_max3_f32 v19, v19, v24, v25
    v_max3_f32 v19, v19, v26, v27
    v_max3_f32 v19, v19, v28, v29
    v_max3_f32 v19, v19, v30, v31
    v_max3_f32 v19, v19, v32, v33
    v_max3_f32 v19, v19, v34, v35
    v_max3_f32 v19, v19, v36, v37
    v_max3_f32 v19, v19, v38, v39
    v_max3_f32 v19, v19, v40, v41
    v_max3_f32 v19, v19, v42, v43
    v_max3_f32 v19, v19, v44, v45
    v_max3_f32 v19, v19, v46, v47
    v_max3_f32 v19, v19, v48, v49
    v_max3_f32 v19, v19, v50, v51
    s_add_u32 s77, s77, 7168
    s_sub_u32 s34, s34, 1
    s_cmp_lg_u32 s34, 0
    s_cbranch_scc1 fb1_32
    v_mov_b32 v16, v19
    s_nop 1
    v_permlane32_swap_b32 v19, v16
    s_nop 1
    v_max_f32 v19, v19, v16
    v_sub_f32 v12, 0, v19
    v_cvt_pk_bf16_f32 v13, v12, v12
    v_and_b32 v14, 0xffff0000, v13
    v_sub_f32 v14, v12, v14
    v_cvt_pk_bf16_f32 v13, v12, v14
    v_and_b32 v15, 0xffff0000, v13
    v_sub_f32 v14, v14, v15
    v_mov_b32 v15, 0
    v_cvt_pk_bf16_f32 v14, v14, v15
    v_cndmask_b32 v112, v112, v13, s[62:63]
    v_cndmask_b32 v113, v113, v14, s[62:63]
    v_mov_b32 v52, 0
    v_mov_b32 v53, 0
    v_mov_b32 v54, 0
    v_mov_b32 v55, 0
    v_mov_b32 v56, 0
    v_mov_b32 v57, 0
    v_mov_b32 v58, 0
    v_mov_b32 v59, 0
    v_mov_b32 v60, 0
    v_mov_b32 v61, 0
    v_mov_b32 v62, 0
    v_mov_b32 v63, 0
    v_mov_b32 v64, 0
    v_mov_b32 v65, 0
    v_mov_b32 v66, 0
    v_mov_b32 v67, 0
    s_mov_b32 s77, 10485760
    s_mov_b32 s34, 64
fb2_33:
    s_and_b32 s78, s34, 1
    s_lshl_b32 s79, s78, 10
    s_add_u32 s79, s79, s77
    s_lshl_b32 s80, s78, 9
    s_add_u32 s80, s80, s77
    s_lshl_b32 s81, s78, 11
    s_add_u32 s81, s81, s77
    s_add_u32 s81, s81, 3072
    buffer_load_dwordx4 v[80:83], v17, s[20:23], s79 offen sc1
    buffer_load_dwordx2 v[88:89], v11, s[20:23], s80 offen offset:2048 sc1
    buffer_load_dwordx4 v[68:71], v17, s[20:23], s81 offen sc1
    buffer_load_dwordx4 v[72:75], v17, s[20:23], s81 offen offset:1024 sc1
    s_waitcnt vmcnt(0)
    v_mfma_f32_32x32x16_bf16 v[20:35], v[80:83], v[76:79], 0
    s_nop 10
    v_mfma_f32_32x32x8_bf16 v[20:35], v[88:89], v[112:113], v[20:35]
    s_nop 15
    v_exp_f32 v20, v20
    v_exp_f32 v21, v21
    v_exp_f32 v22, v22
    v_exp_f32 v23, v23
    v_exp_f32 v24, v24
    v_exp_f32 v25, v25
    v_exp_f32 v26, v26
    v_exp_f32 v27, v27
    v_exp_f32 v28, v28
    v_exp_f32 v29, v29
    v_exp_f32 v30, v30
    v_exp_f32 v31, v31
    v_exp_f32 v32, v32
    v_exp_f32 v33, v33
    v_exp_f32 v34, v34
    v_exp_f32 v35, v35
    s_nop 0
    v_cvt_pk_bf16_f32 v96, v20, v21
    v_cvt_pk_bf16_f32 v97, v22, v23
    v_cvt_pk_bf16_f32 v98, v24, v25
    v_cvt_pk_bf16_f32 v99, v26, v27
    v_cvt_pk_bf16_f32 v100, v28, v29
    v_cvt_pk_bf16_f32 v101, v30, v31
    v_cvt_pk_bf16_f32 v102, v32, v33
    v_cvt_pk_bf16_f32 v103, v34, v35
    s_nop 1
    v_mfma_f32_32x32x16_bf16 v[52:67], v[68:71], v[96:99], v[52:67]
    v_mfma_f32_32x32x16_bf16 v[52:67], v[72:75], v[100:103], v[52:67]
    s_mul_i32 s78, s78, 7168
    s_add_u32 s77, s77, s78
    s_sub_u32 s34, s34, 1
    s_cmp_lg_u32 s34, 0
    s_cbranch_scc1 fb2_33
    s_nop 15
    s_branch aout_25
aux2_7:
    s_mov_b32 s4, s76
    s_mov_b32 s5, s77
    s_mov_b32 s6, 256
    s_mov_b32 s7, 0x20000
    s_or_b32 s44, s2, s26
    s_cmp_lg_u32 s44, 0
    s_cbranch_scc1 nononce_34
    s_memrealtime s[44:45]
    s_waitcnt lgkmcnt(0)
    s_or_b32 s44, s44, 1
    v_mov_b32 v4, s44
    s_mov_b64 exec, 1
    buffer_store_dword v4, off, s[4:7], 0 sc1
    s_mov_b64 exec, -1
nononce_34:
    s_and_b32 s56, s28, 3
    v_lshrrev_b32 v4, 1, v3
    v_and_b32 v4, 7, v4
    v_xor_b32 v4, v4, v2
    s_lshl_b32 s44, s26, 1
    v_xor_b32 v4, s44, v4
    v_lshlrev_b32 v7, 7, v3
    v_lshl_add_u32 v4, v4, 4, v7
    s_lshl_b32 s44, s56, 12
    v_add_u32 v25, s44, v4
    v_bfe_u32 v4, v1, 2, 2
    v_lshl_add_u32 v4, v2, 3, v4
    v_mul_u32_u24 v4, 40, v4
    v_bfe_u32 v7, v1, 4, 1
    v_and_b32 v8, 3, v1
    v_lshl_add_u32 v7, v7, 2, v8
    v_min_u32 v7, 4, v7
    v_lshl_add_u32 v4, v7, 3, v4
    s_mul_i32 s44, s26, 640
    s_add_u32 s44, s44, 147456
    v_add_u32 v26, s44, v4
    v_mov_b32 v60, 0
    v_mov_b32 v61, 0
    v_mov_b32 v62, 0
    v_mov_b32 v63, 0
    v_mov_b32 v64, 0
    v_mov_b32 v65, 0
    v_mov_b32 v66, 0
    v_mov_b32 v67, 0
    v_mov_b32 v68, 0
    v_mov_b32 v69, 0
    v_mov_b32 v70, 0
    v_mov_b32 v71, 0
    v_mov_b32 v72, 0
    v_mov_b32 v73, 0
    v_mov_b32 v74, 0
    v_mov_b32 v75, 0
    s_add_u32 m0, s36, 16384
    s_add_u32 s34, s57, 0
    buffer_load_dwordx4 v20, s[8:11], s34 offen lds
    s_add_u32 m0, s36, 17408
    s_add_u32 s34, s57, 0
    buffer_load_dwordx4 v21, s[8:11], s34 offen lds
    s_add_u32 m0, s36, 18432
    s_add_u32 s34, s57, 20480
    buffer_load_dwordx4 v20, s[8:11], s34 offen lds
    s_add_u32 m0, s36, 19456
    s_add_u32 s34, s57, 20480
    buffer_load_dwordx4 v21, s[8:11], s34 offen lds
    s_cmp_eq_u32 s40, 0
    s_cbranch_scc1 nokv_35
    s_add_u32 m0, s38, 3072
    s_nop 0
    buffer_load_dwordx4 v24, s[16:19], s59 offen lds
nokv_35:
    s_lshl_b32 s41, s27, 10
    s_and_b32 s44, s28, 11
    s_cmp_eq_u32 s44, 0
    s_cselect_b32 s42, 1, 0
    s_cmp_eq_u32 s26, 3
    s_cselect_b32 s42, s42, 0
    s_waitcnt vmcnt(4)
    s_barrier
    s_cmp_eq_u32 s54, 0
    s_cbranch_scc1 kvs_36
    ds_read_b128 v[76:79], v25 offset:0
    ds_read_b64_tr_b16 v[80:81], v26 offset:0
    ds_read_b64_tr_b16 v[82:83], v26 offset:160
kvs_36:
    s_and_b32 s35, s100, 7
    s_xor_b32 s35, s35, 2
    s_mul_i32 s33, s32, s35
    s_mul_i32 s34, s35, 2560
    s_lshl_b32 s35, s35, 7
    s_cmp_eq_u32 s40, 0
    s_cbranch_scc1 nokv_37
    s_add_u32 m0, s38, 6144
    s_nop 0
    buffer_load_dwordx4 v24, s[16:19], s34 offen lds
nokv_37:
    s_add_u32 m0, s36, 32768
    s_add_u32 s34, s35, 0
    buffer_load_dwordx4 v20, s[8:11], s34 offen lds
    s_add_u32 m0, s36, 33792
    s_add_u32 s34, s35, 0
    buffer_load_dwordx4 v21, s[8:11], s34 offen lds
    s_add_u32 m0, s36, 34816
    s_add_u32 s34, s35, 20480
    buffer_load_dwordx4 v20, s[8:11], s34 offen lds
    s_add_u32 m0, s36, 35840
    s_add_u32 s34, s35, 20480
    buffer_load_dwordx4 v21, s[8:11], s34 offen lds
    s_add_u32 m0, s37, 16384
    s_nop 0
    buffer_load_dwordx4 v22, s[12:15], s33 offen lds
    s_add_u32 s33, s33, s31
    s_add_u32 m0, s37, 17408
    s_nop 0
    buffer_load_dwordx4 v23, s[12:15], s33 offen lds
    s_add_u32 s33, s33, s31
    s_add_u32 m0, s37, 18432
    s_nop 0
    buffer_load_dwordx4 v22, s[12:15], s33 offen lds
    s_add_u32 s33, s33, s31
    s_add_u32 m0, s37, 19456
    s_nop 0
    buffer_load_dwordx4 v23, s[12:15], s33 offen lds
    s_add_u32 s33, s33, s31
    s_add_u32 m0, s37, 20480
    s_nop 0
    buffer_load_dwordx4 v22, s[12:15], s33 offen lds
    s_add_u32 s33, s33, s31
    s_add_u32 m0, s37, 21504
    s_nop 0
    buffer_load_dwordx4 v23, s[12:15], s33 offen lds
    s_add_u32 s33, s33, s31
    s_add_u32 m0, s37, 22528
    s_nop 0
    buffer_load_dwordx4 v22, s[12:15], s33 offen lds
    s_add_u32 s33, s33, s31
    s_add_u32 m0, s37, 23552
    s_nop 0
    buffer_load_dwordx4 v23, s[12:15], s33 offen lds
    s_cmp_eq_u32 s54, 0
    s_cbranch_scc1 kvs_38
    s_waitcnt lgkmcnt(0)
    v_mfma_f32_32x32x16_bf16 v[60:75], v[80:83], v[76:79], v[60:75]
kvs_38:
    s_waitcnt vmcnt(12)
    s_barrier
    s_cmp_eq_u32 s54, 0
    s_cbranch_scc1 kvs_39
    ds_read_b128 v[76:79], v25 offset:16384
    ds_read_b64_tr_b16 v[80:81], v26 offset:3072
    ds_read_b64_tr_b16 v[82:83], v26 offset:3232
kvs_39:
    s_and_b32 s35, s100, 7
    s_xor_b32 s35, s35, 3
    s_mul_i32 s33, s32, s35
    s_mul_i32 s34, s35, 2560
    s_lshl_b32 s35, s35, 7
    s_cmp_eq_u32 s40, 0
    s_cbranch_scc1 nokv_40
    s_add_u32 m0, s38, 0
    s_nop 0
    buffer_load_dwordx4 v24, s[16:19], s34 offen lds
nokv_40:
    s_add_u32 m0, s36, 0
    s_add_u32 s34, s35, 0
    buffer_load_dwordx4 v20, s[8:11], s34 offen lds
    s_add_u32 m0, s36, 1024
    s_add_u32 s34, s35, 0
    buffer_load_dwordx4 v21, s[8:11], s34 offen lds
    s_add_u32 m0, s36, 2048
    s_add_u32 s34, s35, 20480
    buffer_load_dwordx4 v20, s[8:11], s34 offen lds
    s_add_u32 m0, s36, 3072
    s_add_u32 s34, s35, 20480
    buffer_load_dwordx4 v21, s[8:11], s34 offen lds
    s_add_u32 m0, s37, 0
    s_nop 0
    buffer_load_dwordx4 v22, s[12:15], s33 offen lds
    s_add_u32 s33, s33, s31
    s_add_u32 m0, s37, 1024
    s_nop 0
    buffer_load_dwordx4 v23, s[12:15], s33 offen lds
    s_add_u32 s33, s33, s31
    s_add_u32 m0, s37, 2048
    s_nop 0
    buffer_load_dwordx4 v22, s[12:15], s33 offen lds
    s_add_u32 s33, s33, s31
    s_add_u32 m0, s37, 3072
    s_nop 0
    buffer_load_dwordx4 v23, s[12:15], s33 offen lds
    s_add_u32 s33, s33, s31
    s_add_u32 m0, s37, 4096
    s_nop 0
    buffer_load_dwordx4 v22, s[12:15], s33 offen lds
    s_add_u32 s33, s33, s31
    s_add_u32 m0, s37, 5120
    s_nop 0
    buffer_load_dwordx4 v23, s[12:15], s33 offen lds
    s_add_u32 s33, s33, s31
    s_add_u32 m0, s37, 6144
    s_nop 0
    buffer_load_dwordx4 v22, s[12:15], s33 offen lds
    s_add_u32 s33, s33, s31
    s_add_u32 m0, s37, 7168
    s_nop 0
    buffer_load_dwordx4 v23, s[12:15], s33 offen lds
    s_cmp_eq_u32 s54, 0
    s_cbranch_scc1 kvs_41
    s_waitcnt lgkmcnt(0)
    v_mfma_f32_32x32x16_bf16 v[60:75], v[80:83], v[76:79], v[60:75]
kvs_41:
    s_waitcnt vmcnt(12)
    s_barrier
    s_cmp_eq_u32 s54, 0
    s_cbranch_scc1 kvs_42
    ds_read_b128 v[76:79], v25 offset:32768
    ds_read_b64_tr_b16 v[80:81], v26 offset:6144
    ds_read_b64_tr_b16 v[82:83], v26 offset:6304
kvs_42:
    s_and_b32 s35, s100, 7
    s_xor_b32 s35, s35, 4
    s_mul_i32 s33, s32, s35
    s_mul_i32 s34, s35, 2560
    s_lshl_b32 s35, s35, 7
    s_cmp_eq_u32 s40, 0
    s_cbranch_scc1 nokv_43
    s_add_u32 m0, s38, 3072
    s_nop 0
    buffer_load_dwordx4 v24, s[16:19], s34 offen lds
nokv_43:
    s_add_u32 m0, s36, 16384
    s_add_u32 s34, s35, 0
    buffer_load_dwordx4 v20, s[8:11], s34 offen lds
    s_add_u32 m0, s36, 17408
    s_add_u32 s34, s35, 0
    buffer_load_dwordx4 v21, s[8:11], s34 offen lds
    s_add_u32 m0, s36, 18432
    s_add_u32 s34, s35, 20480
    buffer_load_dwordx4 v20, s[8:11], s34 offen lds
    s_add_u32 m0, s36, 19456
    s_add_u32 s34, s35, 20480
    buffer_load_dwordx4 v21, s[8:11], s34 offen lds
    s_add_u32 m0, s37, 8192
    s_nop 0
    buffer_load_dwordx4 v22, s[12:15], s33 offen lds
    s_add_u32 s33, s33, s31
    s_add_u32 m0, s37, 9216
    s_nop 0
    buffer_load_dwordx4 v23, s[12:15], s33 offen lds
    s_add_u32 s33, s33, s31
    s_add_u32 m0, s37, 10240
    s_nop 0
    buffer_load_dwordx4 v22, s[12:15], s33 offen lds
    s_add_u32 s33, s33, s31
    s_add_u32 m0, s37, 11264
    s_nop 0
    buffer_load_dwordx4 v23, s[12:15], s33 offen lds
    s_add_u32 s33, s33, s31
    s_add_u32 m0, s37, 12288
    s_nop 0
    buffer_load_dwordx4 v22, s[12:15], s33 offen lds
    s_add_u32 s33, s33, s31
    s_add_u32 m0, s37, 13312
    s_nop 0
    buffer_load_dwordx4 v23, s[12:15], s33 offen lds
    s_add_u32 s33, s33, s31
    s_add_u32 m0, s37, 14336
    s_nop 0
    buffer_load_dwordx4 v22, s[12:15], s33 offen lds
    s_add_u32 s33, s33, s31
    s_add_u32 m0, s37, 15360
    s_nop 0
    buffer_load_dwordx4 v23, s[12:15], s33 offen lds
    s_cmp_eq_u32 s54, 0
    s_cbranch_scc1 kvs_44
    s_waitcnt lgkmcnt(0)
    v_mfma_f32_32x32x16_bf16 v[60:75], v[80:83], v[76:79], v[60:75]
kvs_44:
    s_cmp_eq_u32 s42, 0
    s_cbranch_scc1 nokvcs_45
    s_mul_i32 s44, s27, 40
    v_add_u32 v5, s44, v2
    v_mul_u32_u24 v6, 40, v5
    v_lshl_add_u32 v6, v3, 2, v6
    buffer_load_dword v38, v6, s[16:19], 0 offen offset:0
    buffer_load_dword v39, v6, s[16:19], 0 offen offset:80
    buffer_load_dword v40, v6, s[16:19], 0 offen offset:160
    buffer_load_dword v41, v6, s[16:19], 0 offen offset:240
    buffer_load_dword v42, v6, s[16:19], 0 offen offset:320
    buffer_load_dword v43, v6, s[16:19], 0 offen offset:400
    buffer_load_dword v44, v6, s[16:19], 0 offen offset:480
    buffer_load_dword v45, v6, s[16:19], 0 offen offset:560
    buffer_load_dword v46, v6, s[16:19], 0 offen offset:640
    buffer_load_dword v47, v6, s[16:19], 0 offen offset:720
    buffer_load_dword v48, v6, s[16:19], 0 offen offset:800
    buffer_load_dword v49, v6, s[16:19], 0 offen offset:880
    buffer_load_dword v50, v6, s[16:19], 0 offen offset:960
    buffer_load_dword v51, v6, s[16:19], 0 offen offset:1040
    buffer_load_dword v52, v6, s[16:19], 0 offen offset:1120
    buffer_load_dword v53, v6, s[16:19], 0 offen offset:1200
    buffer_load_dword v54, v6, s[16:19], 0 offen offset:1280
    buffer_load_dword v55, v6, s[16:19], 0 offen offset:1360
    buffer_load_dword v56, v6, s[16:19], 0 offen offset:1440
    buffer_load_dword v57, v6, s[16:19], 0 offen offset:1520
nokvcs_45:
    s_waitcnt vmcnt(12)
    s_barrier
    buffer_load_dword v58, off, s[4:7], 0 sc1
    s_cmp_eq_u32 s54, 0
    s_cbranch_scc1 kvs_46
    ds_read_b128 v[76:79], v25 offset:0
    ds_read_b64_tr_b16 v[80:81], v26 offset:0
    ds_read_b64_tr_b16 v[82:83], v26 offset:160
kvs_46:
    s_and_b32 s35, s100, 7
    s_xor_b32 s35, s35, 5
    s_mul_i32 s33, s32, s35
    s_mul_i32 s34, s35, 2560
    s_lshl_b32 s35, s35, 7
    s_cmp_eq_u32 s40, 0
    s_cbranch_scc1 nokv_47
    s_add_u32 m0, s38, 6144
    s_nop 0
    buffer_load_dwordx4 v24, s[16:19], s34 offen lds
nokv_47:
    s_add_u32 m0, s36, 32768
    s_add_u32 s34, s35, 0
    buffer_load_dwordx4 v20, s[8:11], s34 offen lds
    s_add_u32 m0, s36, 33792
    s_add_u32 s34, s35, 0
    buffer_load_dwordx4 v21, s[8:11], s34 offen lds
    s_add_u32 m0, s36, 34816
    s_add_u32 s34, s35, 20480
    buffer_load_dwordx4 v20, s[8:11], s34 offen lds
    s_add_u32 m0, s36, 35840
    s_add_u32 s34, s35, 20480
    buffer_load_dwordx4 v21, s[8:11], s34 offen lds
    s_add_u32 m0, s37, 16384
    s_nop 0
    buffer_load_dwordx4 v22, s[12:15], s33 offen lds
    s_add_u32 s33, s33, s31
    s_add_u32 m0, s37, 17408
    s_nop 0
    buffer_load_dwordx4 v23, s[12:15], s33 offen lds
    s_add_u32 s33, s33, s31
    s_add_u32 m0, s37, 18432
    s_nop 0
    buffer_load_dwordx4 v22, s[12:15], s33 offen lds
    s_add_u32 s33, s33, s31
    s_add_u32 m0, s37, 19456
    s_nop 0
    buffer_load_dwordx4 v23, s[12:15], s33 offen lds
    s_add_u32 s33, s33, s31
    s_add_u32 m0, s37, 20480
    s_nop 0
    buffer_load_dwordx4 v22, s[12:15], s33 offen lds
    s_add_u32 s33, s33, s31
    s_add_u32 m0, s37, 21504
    s_nop 0
    buffer_load_dwordx4 v23, s[12:15], s33 offen lds
    s_add_u32 s33, s33, s31
    s_add_u32 m0, s37, 22528
    s_nop 0
    buffer_load_dwordx4 v22, s[12:15], s33 offen lds
    s_add_u32 s33, s33, s31
    s_add_u32 m0, s37, 23552
    s_nop 0
    buffer_load_dwordx4 v23, s[12:15], s33 offen lds
    s_cmp_eq_u32 s54, 0
    s_cbranch_scc1 kvs_48
    s_waitcnt lgkmcnt(0)
    v_mfma_f32_32x32x16_bf16 v[60:75], v[80:83], v[76:79], v[60:75]
kvs_48:
    s_cmp_eq_u32 s42, 0
    s_cbranch_scc1 nokvcs2_49
    s_waitcnt vmcnt(13)
    v_lshlrev_b32 v4, 16, v38
    v_and_b32 v5, 0xffff0000, v38
    v_lshlrev_b32 v6, 16, v39
    v_and_b32 v7, 0xffff0000, v39
    v_add_f32 v4, v4, v6
    v_add_f32 v5, v5, v7
    v_lshlrev_b32 v6, 16, v40
    v_and_b32 v7, 0xffff0000, v40
    v_add_f32 v4, v4, v6
    v_add_f32 v5, v5, v7
    v_lshlrev_b32 v6, 16, v41
    v_and_b32 v7, 0xffff0000, v41
    v_add_f32 v4, v4, v6
    v_add_f32 v5, v5, v7
    v_lshlrev_b32 v6, 16, v42
    v_and_b32 v7, 0xffff0000, v42
    v_add_f32 v4, v4, v6
    v_add_f32 v5, v5, v7
    v_lshlrev_b32 v6, 16, v43
    v_and_b32 v7, 0xffff0000, v43
    v_add_f32 v4, v4, v6
    v_add_f32 v5, v5, v7
    v_lshlrev_b32 v6, 16, v44
    v_and_b32 v7, 0xffff0000, v44
    v_add_f32 v4, v4, v6
    v_add_f32 v5, v5, v7
    v_lshlrev_b32 v6, 16, v45
    v_and_b32 v7, 0xffff0000, v45
    v_add_f32 v4, v4, v6
    v_add_f32 v5, v5, v7
    v_lshlrev_b32 v6, 16, v46
    v_and_b32 v7, 0xffff0000, v46
    v_add_f32 v4, v4, v6
    v_add_f32 v5, v5, v7
    v_lshlrev_b32 v6, 16, v47
    v_and_b32 v7, 0xffff0000, v47
    v_add_f32 v4, v4, v6
    v_add_f32 v5, v5, v7
    v_lshlrev_b32 v6, 16, v48
    v_and_b32 v7, 0xffff0000, v48
    v_add_f32 v4, v4, v6
    v_add_f32 v5, v5, v7
    v_lshlrev_b32 v6, 16, v49
    v_and_b32 v7, 0xffff0000, v49
    v_add_f32 v4, v4, v6
    v_add_f32 v5, v5, v7
    v_lshlrev_b32 v6, 16, v50
    v_and_b32 v7, 0xffff0000, v50
    v_add_f32 v4, v4, v6
    v_add_f32 v5, v5, v7
    v_lshlrev_b32 v6, 16, v51
    v_and_b32 v7, 0xffff0000, v51
    v_add_f32 v4, v4, v6
    v_add_f32 v5, v5, v7
    v_lshlrev_b32 v6, 16, v52
    v_and_b32 v7, 0xffff0000, v52
    v_add_f32 v4, v4, v6
    v_add_f32 v5, v5, v7
    v_lshlrev_b32 v6, 16, v53
    v_and_b32 v7, 0xffff0000, v53
    v_add_f32 v4, v4, v6
    v_add_f32 v5, v5, v7
    v_lshlrev_b32 v6, 16, v54
    v_and_b32 v7, 0xffff0000, v54
    v_add_f32 v4, v4, v6
    v_add_f32 v5, v5, v7
    v_lshlrev_b32 v6, 16, v55
    v_and_b32 v7, 0xffff0000, v55
    v_add_f32 v4, v4, v6
    v_add_f32 v5, v5, v7
    v_lshlrev_b32 v6, 16, v56
    v_and_b32 v7, 0xffff0000, v56
    v_add_f32 v4, v4, v6
    v_add_f32 v5, v5, v7
    v_lshlrev_b32 v6, 16, v57
    v_and_b32 v7, 0xffff0000, v57
    v_add_f32 v4, v4, v6
    v_add_f32 v5, v5, v7
    s_nop 1
    v_permlane32_swap_b32 v4, v5
    s_nop 1
    v_add_f32 v4, v4, v5
    v_cvt_pk_bf16_f32 v5, v4, v4
    v_and_b32 v5, 0xffff0000, v5
    v_sub_f32 v5, v4, v5
    v_cvt_pk_bf16_f32 v4, v4, v5
    v_lshl_add_u32 v5, v3, 1, v2
    v_lshlrev_b32 v6, 2, v5
    v_mov_b32 v7, 0x7f000000
    v_cmp_gt_u32 vcc, 32, v5
    s_lshl_b32 s44, s28, 9
    s_lshl_b32 s45, s27, 7
    s_add_u32 s44, s44, s45
    s_add_u32 s44, s44, 15073280
    v_cndmask_b32 v6, v7, v6, vcc
    buffer_store_dword v4, v6, s[20:23], s44 offen sc1
nokvcs2_49:
    s_waitcnt vmcnt(13)
    s_barrier
    s_cmp_eq_u32 s54, 0
    s_cbranch_scc1 kvs_50
    ds_read_b128 v[76:79], v25 offset:16384
    ds_read_b64_tr_b16 v[80:81], v26 offset:3072
    ds_read_b64_tr_b16 v[82:83], v26 offset:3232
kvs_50:
    s_and_b32 s35, s100, 7
    s_xor_b32 s35, s35, 6
    s_mul_i32 s33, s32, s35
    s_mul_i32 s34, s35, 2560
    s_lshl_b32 s35, s35, 7
    s_cmp_eq_u32 s40, 0
    s_cbranch_scc1 nokv_51
    s_add_u32 m0, s38, 0
    s_nop 0
    buffer_load_dwordx4 v24, s[16:19], s34 offen lds
nokv_51:
    s_add_u32 m0, s36, 0
    s_add_u32 s34, s35, 0
    buffer_load_dwordx4 v20, s[8:11], s34 offen lds
    s_add_u32 m0, s36, 1024
    s_add_u32 s34, s35, 0
    buffer_load_dwordx4 v21, s[8:11], s34 offen lds
    s_add_u32 m0, s36, 2048
    s_add_u32 s34, s35, 20480
    buffer_load_dwordx4 v20, s[8:11], s34 offen lds
    s_add_u32 m0, s36, 3072
    s_add_u32 s34, s35, 20480
    buffer_load_dwordx4 v21, s[8:11], s34 offen lds
    s_add_u32 m0, s37, 0
    s_nop 0
    buffer_load_dwordx4 v22, s[12:15], s33 offen lds
    s_add_u32 s33, s33, s31
    s_add_u32 m0, s37, 1024
    s_nop 0
    buffer_load_dwordx4 v23, s[12:15], s33 offen lds
    s_add_u32 s33, s33, s31
    s_add_u32 m0, s37, 2048
    s_nop 0
    buffer_load_dwordx4 v22, s[12:15], s33 offen lds
    s_add_u32 s33, s33, s31
    s_add_u32 m0, s37, 3072
    s_nop 0
    buffer_load_dwordx4 v23, s[12:15], s33 offen lds
    s_add_u32 s33, s33, s31
    s_add_u32 m0, s37, 4096
    s_nop 0
    buffer_load_dwordx4 v22, s[12:15], s33 offen lds
    s_add_u32 s33, s33, s31
    s_add_u32 m0, s37, 5120
    s_nop 0
    buffer_load_dwordx4 v23, s[12:15], s33 offen lds
    s_add_u32 s33, s33, s31
    s_add_u32 m0, s37, 6144
    s_nop 0
    buffer_load_dwordx4 v22, s[12:15], s33 offen lds
    s_add_u32 s33, s33, s31
    s_add_u32 m0, s37, 7168
    s_nop 0
    buffer_load_dwordx4 v23, s[12:15], s33 offen lds
    s_cmp_eq_u32 s54, 0
    s_cbranch_scc1 kvs_52
    s_waitcnt lgkmcnt(0)
    v_mfma_f32_32x32x16_bf16 v[60:75], v[80:83], v[76:79], v[60:75]
kvs_52:
    s_waitcnt vmcnt(12)
    s_barrier
    s_cmp_eq_u32 s54, 0
    s_cbranch_scc1 kvs_53
    ds_read_b128 v[76:79], v25 offset:32768
    ds_read_b64_tr_b16 v[80:81], v26 offset:6144
    ds_read_b64_tr_b16 v[82:83], v26 offset:6304
kvs_53:
    s_and_b32 s35, s100, 7
    s_xor_b32 s35, s35, 7
    s_mul_i32 s33, s32, s35
    s_mul_i32 s34, s35, 2560
    s_lshl_b32 s35, s35, 7
    s_cmp_eq_u32 s40, 0
    s_cbranch_scc1 nokv_54
    s_add_u32 m0, s38, 3072
    s_nop 0
    buffer_load_dwordx4 v24, s[16:19], s34 offen lds
nokv_54:
    s_add_u32 m0, s36, 16384
    s_add_u32 s34, s35, 0
    buffer_load_dwordx4 v20, s[8:11], s34 offen lds
    s_add_u32 m0, s36, 17408
    s_add_u32 s34, s35, 0
    buffer_load_dwordx4 v21, s[8:11], s34 offen lds
    s_add_u32 m0, s36, 18432
    s_add_u32 s34, s35, 20480
    buffer_load_dwordx4 v20, s[8:11], s34 offen lds
    s_add_u32 m0, s36, 19456
    s_add_u32 s34, s35, 20480
    buffer_load_dwordx4 v21, s[8:11], s34 offen lds
    s_add_u32 m0, s37, 8192
    s_nop 0
    buffer_load_dwordx4 v22, s[12:15], s33 offen lds
    s_add_u32 s33, s33, s31
    s_add_u32 m0, s37, 9216
    s_nop 0
    buffer_load_dwordx4 v23, s[12:15], s33 offen lds
    s_add_u32 s33, s33, s31
    s_add_u32 m0, s37, 10240
    s_nop 0
    buffer_load_dwordx4 v22, s[12:15], s33 offen lds
    s_add_u32 s33, s33, s31
    s_add_u32 m0, s37, 11264
    s_nop 0
    buffer_load_dwordx4 v23, s[12:15], s33 offen lds
    s_add_u32 s33, s33, s31
    s_add_u32 m0, s37, 12288
    s_nop 0
    buffer_load_dwordx4 v22, s[12:15], s33 offen lds
    s_add_u32 s33, s33, s31
    s_add_u32 m0, s37, 13312
    s_nop 0
    buffer_load_dwordx4 v23, s[12:15], s33 offen lds
    s_add_u32 s33, s33, s31
    s_add_u32 m0, s37, 14336
    s_nop 0
    buffer_load_dwordx4 v22, s[12:15], s33 offen lds
    s_add_u32 s33, s33, s31
    s_add_u32 m0, s37, 15360
    s_nop 0
    buffer_load_dwordx4 v23, s[12:15], s33 offen lds
    s_cmp_eq_u32 s54, 0
    s_cbranch_scc1 kvs_55
    s_waitcnt lgkmcnt(0)
    v_mfma_f32_32x32x16_bf16 v[60:75], v[80:83], v[76:79], v[60:75]
kvs_55:
    s_mov_b32 s93, 400000
np_56:
    v_readfirstlane_b32 s98, v58
    s_cmp_lg_u32 s98, 0
    s_cbranch_scc1 npd_57
    s_sub_u32 s93, s93, 1
    s_cbranch_scc1 npd_57
    buffer_load_dword v58, off, s[4:7], 0 sc1
    s_waitcnt vmcnt(0)
    s_branch np_56
npd_57:
    s_xor_b32 s99, s98, 1515870810
    s_lshl_b32 s44, s28, 9
    s_lshl_b32 s45, s27, 7
    s_add_u32 s44, s44, s45
    s_add_u32 s44, s44, 19169280
    s_cmp_eq_u32 s42, 0
    s_cbranch_scc1 nokcf_59
    v_mov_b32 v6, s98
    v_mov_b32 v7, s99
    s_mov_b64 exec, 1
    buffer_store_dwordx2 v[6:7], off, s[20:23], s44 sc1
    s_mov_b64 exec, -1
nokcf_59:
    s_waitcnt vmcnt(12)
    s_barrier
    s_cmp_eq_u32 s54, 0
    s_cbranch_scc1 kvs_60
    ds_read_b128 v[76:79], v25 offset:0
    ds_read_b64_tr_b16 v[80:81], v26 offset:0
    ds_read_b64_tr_b16 v[82:83], v26 offset:160
kvs_60:
    s_and_b32 s35, s100, 1
    s_xor_b32 s35, s35, 8
    s_mul_i32 s33, s32, s35
    s_mul_i32 s34, s35, 2560
    s_lshl_b32 s35, s35, 7
    s_cmp_eq_u32 s40, 0
    s_cbranch_scc1 nokv_61
    s_add_u32 m0, s38, 6144
    s_nop 0
    buffer_load_dwordx4 v24, s[16:19], s34 offen lds
nokv_61:
    s_add_u32 m0, s36, 32768
    s_add_u32 s34, s35, 0
    buffer_load_dwordx4 v20, s[8:11], s34 offen lds
    s_add_u32 m0, s36, 33792
    s_add_u32 s34, s35, 0
    buffer_load_dwordx4 v21, s[8:11], s34 offen lds
    s_add_u32 m0, s36, 34816
    s_add_u32 s34, s35, 20480
    buffer_load_dwordx4 v20, s[8:11], s34 offen lds
    s_add_u32 m0, s36, 35840
    s_add_u32 s34, s35, 20480
    buffer_load_dwordx4 v21, s[8:11], s34 offen lds
    s_add_u32 m0, s37, 16384
    s_nop 0
    buffer_load_dwordx4 v22, s[12:15], s33 offen lds
    s_add_u32 s33, s33, s31
    s_add_u32 m0, s37, 17408
    s_nop 0
    buffer_load_dwordx4 v23, s[12:15], s33 offen lds
    s_add_u32 s33, s33, s31
    s_add_u32 m0, s37, 18432
    s_nop 0
    buffer_load_dwordx4 v22, s[12:15], s33 offen lds
    s_add_u32 s33, s33, s31
    s_add_u32 m0, s37, 19456
    s_nop 0
    buffer_load_dwordx4 v23, s[12:15], s33 offen lds
    s_add_u32 s33, s33, s31
    s_add_u32 m0, s37, 20480
    s_nop 0
    buffer_load_dwordx4 v22, s[12:15], s33 offen lds
    s_add_u32 s33, s33, s31
    s_add_u32 m0, s37, 21504
    s_nop 0
    buffer_load_dwordx4 v23, s[12:15], s33 offen lds
    s_add_u32 s33, s33, s31
    s_add_u32 m0, s37, 22528
    s_nop 0
    buffer_load_dwordx4 v22, s[12:15], s33 offen lds
    s_add_u32 s33, s33, s31
    s_add_u32 m0, s37, 23552
    s_nop 0
    buffer_load_dwordx4 v23, s[12:15], s33 offen lds
    s_cmp_eq_u32 s54, 0
    s_cbranch_scc1 kvs_62
    s_waitcnt lgkmcnt(0)
    v_mfma_f32_32x32x16_bf16 v[60:75], v[80:83], v[76:79], v[60:75]
kvs_62:
    s_waitcnt vmcnt(12)
    s_barrier
    s_cmp_eq_u32 s54, 0
    s_cbranch_scc1 kvs_63
    ds_read_b128 v[76:79], v25 offset:16384
    ds_read_b64_tr_b16 v[80:81], v26 offset:3072
    ds_read_b64_tr_b16 v[82:83], v26 offset:3232
kvs_63:
    v_lshlrev_b32 v12, 3, v1
    v_lshlrev_b32 v14, 7, v1
    v_and_b32 v15, 0x780, v14
    s_cmp_lg_u32 s26, 3
    s_cbranch_scc1 nop3_64
    s_lshl_b32 s44, s27, 13
    s_add_u32 s44, s44, 18874368
    s_lshl_b32 s45, s28, 13
    s_add_u32 s45, s45, 19005440
    s_and_b32 s58, s28, 4
    s_lshl_b32 s58, s58, 9
    s_add_u32 s58, s58, 19169280
    s_mov_b32 s60, s44
    s_mov_b32 s61, s45
    s_lshr_b32 s59, s29, 1
    s_lshl_b32 s59, s59, 13
    s_add_u32 s59, s59, 18874368
    buffer_load_dwordx2 v[90:91], v14, s[20:23], s59 offen sc1
    buffer_load_dwordx2 v[84:85], v14, s[20:23], s60 offen sc1
    buffer_load_dwordx2 v[86:87], v14, s[20:23], s61 offen sc1
    buffer_load_dwordx2 v[88:89], v15, s[20:23], s58 offen sc1
nop3_64:
    s_and_b32 s35, s100, 1
    s_xor_b32 s35, s35, 9
    s_mul_i32 s33, s32, s35
    s_mul_i32 s34, s35, 2560
    s_lshl_b32 s35, s35, 7
    s_cmp_eq_u32 s40, 0
    s_cbranch_scc1 nokv_65
    s_add_u32 m0, s38, 0
    s_nop 0
    buffer_load_dwordx4 v24, s[16:19], s34 offen lds
nokv_65:
    s_add_u32 m0, s36, 0
    s_add_u32 s34, s35, 0
    buffer_load_dwordx4 v20, s[8:11], s34 offen lds
    s_add_u32 m0, s36, 1024
    s_add_u32 s34, s35, 0
    buffer_load_dwordx4 v21, s[8:11], s34 offen lds
    s_add_u32 m0, s36, 2048
    s_add_u32 s34, s35, 20480
    buffer_load_dwordx4 v20, s[8:11], s34 offen lds
    s_add_u32 m0, s36, 3072
    s_add_u32 s34, s35, 20480
    buffer_load_dwordx4 v21, s[8:11], s34 offen lds
    s_add_u32 m0, s37, 0
    s_nop 0
    buffer_load_dwordx4 v22, s[12:15], s33 offen lds
    s_add_u32 s33, s33, s31
    s_add_u32 m0, s37, 1024
    s_nop 0
    buffer_load_dwordx4 v23, s[12:15], s33 offen lds
    s_add_u32 s33, s33, s31
    s_add_u32 m0, s37, 2048
    s_nop 0
    buffer_load_dwordx4 v22, s[12:15], s33 offen lds
    s_add_u32 s33, s33, s31
    s_add_u32 m0, s37, 3072
    s_nop 0
    buffer_load_dwordx4 v23, s[12:15], s33 offen lds
    s_add_u32 s33, s33, s31
    s_add_u32 m0, s37, 4096
    s_nop 0
    buffer_load_dwordx4 v22, s[12:15], s33 offen lds
    s_add_u32 s33, s33, s31
    s_add_u32 m0, s37, 5120
    s_nop 0
    buffer_load_dwordx4 v23, s[12:15], s33 offen lds
    s_add_u32 s33, s33, s31
    s_add_u32 m0, s37, 6144
    s_nop 0
    buffer_load_dwordx4 v22, s[12:15], s33 offen lds
    s_add_u32 s33, s33, s31
    s_add_u32 m0, s37, 7168
    s_nop 0
    buffer_load_dwordx4 v23, s[12:15], s33 offen lds
    s_cmp_eq_u32 s54, 0
    s_cbranch_scc1 kvs_66
    s_waitcnt lgkmcnt(0)
    v_mfma_f32_32x32x16_bf16 v[60:75], v[80:83], v[76:79], v[60:75]
kvs_66:
    s_cmp_lg_u32 s26, 3
    s_cbranch_scc1 nop3b_67
    s_waitcnt vmcnt(12)
    v_cmp_eq_u64 vcc, s[98:99], v[84:85]
    v_cmp_eq_u64 s[46:47], s[98:99], v[86:87]
    v_cmp_eq_u64 s[44:45], s[98:99], v[88:89]
    v_cmp_eq_u64 s[48:49], s[98:99], v[90:91]
    s_nop 1
    s_and_b64 vcc, vcc, s[46:47]
    s_and_b64 vcc, vcc, s[44:45]
    s_and_b64 vcc, vcc, s[48:49]
    s_cmp_eq_u64 vcc, -1
    s_cbranch_scc1 nop3b_67
    s_mov_b32 s93, 400000
poll_68:
    buffer_load_dwordx2 v[84:85], v14, s[20:23], s60 offen sc1
    buffer_load_dwordx2 v[86:87], v14, s[20:23], s61 offen sc1
    buffer_load_dwordx2 v[88:89], v15, s[20:23], s58 offen sc1
    s_waitcnt vmcnt(0)
    v_cmp_eq_u64 vcc, s[98:99], v[84:85]
    v_cmp_eq_u64 s[46:47], s[98:99], v[86:87]
    v_cmp_eq_u64 s[48:49], s[98:99], v[88:89]
    s_nop 1
    s_and_b64 vcc, vcc, s[46:47]
    s_and_b64 vcc, vcc, s[48:49]
    s_cmp_eq_u64 vcc, -1
    s_cbranch_scc1 polld_69
    s_sub_u32 s93, s93, 1
    s_cbranch_scc1 polld_69
    s_sleep 4
    s_branch poll_68
polld_69:
    s_mov_b32 s93, 400000
poll_70:
    buffer_load_dwordx2 v[84:85], v14, s[20:23], s59 offen sc1
    s_waitcnt vmcnt(0)
    v_cmp_eq_u64 vcc, s[98:99], v[84:85]
    s_nop 1
    s_cmp_eq_u64 vcc, -1
    s_cbranch_scc1 polld_71
    s_sub_u32 s93, s93, 1
    s_cbranch_scc1 polld_71
    s_sleep 4
    s_branch poll_70
polld_71:
nop3b_67:
    s_waitcnt vmcnt(12)
    s_barrier
    s_cmp_eq_u32 s54, 0
    s_cbranch_scc1 kvs_72
    ds_read_b128 v[76:79], v25 offset:32768
    ds_read_b64_tr_b16 v[80:81], v26 offset:6144
    ds_read_b64_tr_b16 v[82:83], v26 offset:6304
kvs_72:
    s_cmp_eq_u32 s54, 0
    s_cbranch_scc1 kvs_73
    s_waitcnt lgkmcnt(0)
    v_mfma_f32_32x32x16_bf16 v[60:75], v[80:83], v[76:79], v[60:75]
kvs_73:
    v_lshlrev_b32 v13, 4, v1
    s_lshl_b32 s44, s28, 14
    s_lshl_b32 s45, s26, 12
    s_add_u32 s44, s44, s45
    s_add_u32 s44, s44, 14811136
    s_add_u32 m0, s45, 16384
    s_nop 0
    buffer_load_dwordx4 v13, s[20:23], s44 offen lds
    s_add_u32 s44, s44, 1024
    s_add_u32 m0, s45, 17408
    s_nop 0
    buffer_load_dwordx4 v13, s[20:23], s44 offen lds
    s_add_u32 s44, s44, 1024
    s_add_u32 m0, s45, 18432
    s_nop 0
    buffer_load_dwordx4 v13, s[20:23], s44 offen lds
    s_add_u32 s44, s44, 1024
    s_add_u32 m0, s45, 19456
    s_nop 0
    buffer_load_dwordx4 v13, s[20:23], s44 offen lds
    s_add_u32 s44, s44, 1024
    s_cmp_lg_u32 s26, 0
    s_cbranch_scc1 norc_74
    s_lshl_b32 s44, s27, 11
    s_add_u32 s44, s44, 14745600
    s_mov_b32 m0, 156672
    s_and_b32 s45, s28, 4
    buffer_load_dwordx4 v13, s[20:23], s44 offen lds
    buffer_load_dwordx4 v13, s[20:23], s44 offen offset:1024 lds
    s_lshl_b32 s45, s45, 9
    s_add_u32 s45, s45, 15073280
    s_mov_b32 m0, 158720
    s_nop 0
    buffer_load_dwordx4 v13, s[20:23], s45 offen lds
    buffer_load_dwordx4 v13, s[20:23], s45 offen offset:1024 lds
norc_74:
    s_waitcnt vmcnt(0)
    s_barrier
    s_cmp_eq_u32 s54, 0
    s_cbranch_scc1 kvs_75
    ds_read_b128 v[76:79], v25 offset:0
    ds_read_b64_tr_b16 v[80:81], v26 offset:0
    ds_read_b64_tr_b16 v[82:83], v26 offset:160
kvs_75:
    s_cmp_eq_u32 s54, 0
    s_cbranch_scc1 kvs_76
    s_waitcnt lgkmcnt(0)
    v_mfma_f32_32x32x16_bf16 v[60:75], v[80:83], v[76:79], v[60:75]
kvs_76:
    s_cmp_eq_u32 s54, 0
    s_cbranch_scc1 nokvfin_80
    s_cmp_lg_u32 s26, 0
    s_cbranch_scc1 nofix_81
    s_lshl_b32 s44, s56, 9
    s_add_u32 s44, s44, 156672
    v_lshl_add_u32 v4, v3, 4, s44
    v_lshlrev_b32 v5, 2, v3
    v_lshl_add_u32 v5, v2, 9, v5
    v_add_u32 v5, 158720, v5
    v_add_u32 v6, 1024, v5
    ds_read_b128 v[84:87], v4
    ds_read2_b32 v[92:93], v5 offset0:0 offset1:32
    ds_read2_b32 v[94:95], v5 offset0:64 offset1:96
    ds_read2_b32 v[96:97], v6 offset0:0 offset1:32
    ds_read2_b32 v[98:99], v6 offset0:64 offset1:96
    s_waitcnt lgkmcnt(4)
    v_mov_b32 v88, v84
    v_mov_b32 v89, v84
    v_mov_b32 v90, v84
    v_mov_b32 v91, v84
    s_waitcnt lgkmcnt(0)
    s_nop 1
    v_mfma_f32_32x32x16_bf16 v[60:75], v[92:95], v[88:91], v[60:75]
    v_mfma_f32_32x32x16_bf16 v[60:75], v[96:99], v[88:91], v[60:75]
    s_branch aux0f_79
nofix_81:
    s_lshl_b32 s44, s26, 12
    v_add_u32 v4, s44, v13
    s_lshl_b32 s44, s26, 2
    s_add_u32 s44, s44, 160864
    v_mov_b32 v5, s44
    v_mov_b32 v6, s98
    s_nop 11
    ds_write_b128 v4, v[60:63] offset:32768
    ds_write_b128 v4, v[64:67] offset:33792
    ds_write_b128 v4, v[68:71] offset:34816
    s_waitcnt lgkmcnt(0)
    ds_write_b32 v5, v6
nokvfin_80:
    s_branch auxp2_77
aux0f_79:
    v_mov_b32 v5, 160864
    s_mov_b32 s93, 3200000
pspin_82:
    ds_read_b128 v[8:11], v5
    s_waitcnt lgkmcnt(0)
    v_xor_b32 v9, s98, v9
    v_xor_b32 v10, s98, v10
    v_xor_b32 v11, s98, v11
    v_or3_b32 v9, v9, v10, v11
    s_nop 0
    v_readfirstlane_b32 s44, v9
    s_cmp_eq_u32 s44, 0
    s_cbranch_scc1 pspind_83
    s_sub_u32 s93, s93, 1
    s_cbranch_scc0 pspin_82
pspind_83:
    ds_read_b128 v[100:103], v13 offset:36864
    ds_read_b128 v[104:107], v13 offset:37888
    ds_read_b128 v[108:111], v13 offset:38912
    ds_read_b128 v[112:115], v13 offset:40960
    ds_read_b128 v[116:119], v13 offset:41984
    ds_read_b128 v[120:123], v13 offset:43008
    ds_read_b128 v[124:127], v13 offset:45056
    ds_read_b128 v[128:131], v13 offset:46080
    ds_read_b128 v[132:135], v13 offset:47104
    s_lshl_b32 s57, s27, 2
    s_add_u32 s57, s57, s56
    s_lshr_b32 s44, s57, 1
    s_mul_i32 s44, s44, 7168
    s_add_u32 s44, s44, 10485760
    s_and_b32 s45, s57, 1
    s_and_b32 s58, s28, 4
    s_lshl_b32 s58, s58, 4
    s_add_u32 s58, s58, s57
    s_lshl_b32 s58, s58, 7
    s_add_u32 s58, s58, 19136512
    s_waitcnt lgkmcnt(0)
    v_add_f32 v60, v60, v100
    v_add_f32 v112, v112, v124
    v_add_f32 v61, v61, v101
    v_add_f32 v113, v113, v125
    v_add_f32 v62, v62, v102
    v_add_f32 v114, v114, v126
    v_add_f32 v63, v63, v103
    v_add_f32 v115, v115, v127
    v_add_f32 v64, v64, v104
    v_add_f32 v116, v116, v128
    v_add_f32 v65, v65, v105
    v_add_f32 v117, v117, v129
    v_add_f32 v66, v66, v106
    v_add_f32 v118, v118, v130
    v_add_f32 v67, v67, v107
    v_add_f32 v119, v119, v131
    v_add_f32 v68, v68, v108
    v_add_f32 v120, v120, v132
    v_add_f32 v69, v69, v109
    v_add_f32 v121, v121, v133
    v_add_f32 v70, v70, v110
    v_add_f32 v122, v122, v134
    v_add_f32 v71, v71, v111
    v_add_f32 v123, v123, v135
    v_add_f32 v60, v60, v112
    v_add_f32 v61, v61, v113
    v_add_f32 v62, v62, v114
    v_add_f32 v63, v63, v115
    v_add_f32 v64, v64, v116
    v_add_f32 v65, v65, v117
    v_add_f32 v66, v66, v118
    v_add_f32 v67, v67, v119
    v_add_f32 v68, v68, v120
    v_add_f32 v69, v69, v121
    v_add_f32 v70, v70, v122
    v_add_f32 v71, v71, v123
    v_mul_f32 v60, v60, v85
    v_mul_f32 v61, v61, v85
    v_mul_f32 v62, v62, v85
    v_mul_f32 v63, v63, v85
    v_mul_f32 v64, v64, v85
    v_mul_f32 v65, v65, v85
    v_mul_f32 v66, v66, v85
    v_mul_f32 v67, v67, v85
    v_mul_f32 v68, v68, v85
    v_mul_f32 v69, v69, v85
    v_mul_f32 v70, v70, v85
    v_mul_f32 v71, v71, v85
    v_cvt_pk_bf16_f32 v100, v60, v61
    v_cvt_pk_bf16_f32 v101, v62, v63
    v_cvt_pk_bf16_f32 v102, v64, v65
    v_cvt_pk_bf16_f32 v103, v66, v67
    v_cvt_pk_bf16_f32 v104, v68, v69
    v_cvt_pk_bf16_f32 v105, v70, v71
    s_bitcmp1_b32 s28, 2
    s_cbranch_scc1 vepi_78
    v_mov_b32 v4, 0x3f803f80
    v_mov_b32 v5, 0x00003f80
    v_cndmask_b32 v104, v104, v4, s[62:63]
    v_cndmask_b32 v105, v105, v5, s[62:63]
    s_lshl_b32 s46, s45, 10
    s_add_u32 s46, s46, s44
    s_lshl_b32 s47, s45, 9
    s_add_u32 s47, s47, s44
    buffer_store_dwordx4 v[100:103], v13, s[20:23], s46 offen sc1
    buffer_store_dwordx2 v[104:105], v12, s[20:23], s47 offen offset:2048 sc1
    s_branch kvflag_84
vepi_78:
    v_mov_b32 v4, 0
    v_cndmask_b32 v104, v104, v4, s[62:63]
    v_cndmask_b32 v105, v105, v4, s[62:63]
    v_mov_b32 v106, 0x00003f80
    v_mov_b32 v107, 0
    v_lshlrev_b32 v4, 6, v3
    v_lshl_add_u32 v4, v2, 3, v4
    ds_write_b64 v4, v[100:101] offset:32768
    ds_write_b64 v4, v[102:103] offset:32784
    ds_write_b64 v4, v[104:105] offset:32800
    ds_write_b64 v4, v[106:107] offset:32816
    v_bfe_u32 v5, v1, 2, 2
    v_lshl_add_u32 v5, v2, 2, v5
    v_lshlrev_b32 v5, 6, v5
    v_bfe_u32 v6, v1, 4, 1
    v_lshl_add_u32 v5, v6, 5, v5
    v_and_b32 v6, 3, v1
    v_lshl_add_u32 v5, v6, 3, v5
    s_waitcnt lgkmcnt(0)
    ds_read_b64_tr_b16 v[108:109], v5 offset:32768
    ds_read_b64_tr_b16 v[110:111], v5 offset:33280
    ds_read_b64_tr_b16 v[112:113], v5 offset:33792
    ds_read_b64_tr_b16 v[114:115], v5 offset:34304
    s_lshl_b32 s46, s45, 11
    s_add_u32 s46, s46, s44
    s_add_u32 s46, s46, 3072
    s_waitcnt lgkmcnt(0)
    buffer_store_dwordx4 v[108:111], v13, s[20:23], s46 offen sc1
    buffer_store_dwordx4 v[112:115], v13, s[20:23], s46 offen offset:1024 sc1
kvflag_84:
    s_waitcnt vmcnt(0)
    v_mov_b32 v6, s98
    v_mov_b32 v7, s99
    s_mov_b64 exec, 1
    buffer_store_dwordx2 v[6:7], off, s[20:23], s58 sc1
    s_mov_b64 exec, -1
auxp2_77:
    s_setprio 3
    s_lshr_b32 s57, s30, 1
    s_and_b32 s58, s30, 1
    s_lshl_b32 s44, s29, 1
    s_add_u32 s59, s44, s58
    s_xor_b32 s60, s59, 1
    s_mul_i32 s44, s57, 320
    s_lshl_b32 s45, s58, 7
    s_add_u32 s61, s44, s45
    s_mov_b32 s12, s88
    s_mov_b32 s13, s89
    s_mov_b32 s14, 2211840
    s_mov_b32 s15, 0x20000
    s_mov_b32 s16, s84
    s_mov_b32 s17, s85
    s_mov_b32 s18, 819200
    s_mov_b32 s19, 0x20000
    s_mul_i32 s44, s26, 27
    s_mul_i32 s41, s59, 108
    s_add_u32 s41, s41, s44
    s_lshl_b32 s41, s41, 10
    s_mul_i32 s42, s60, 108
    s_add_u32 s42, s42, s44
    s_lshl_b32 s42, s42, 10
    s_lshr_b32 s43, s44, 1
    s_mul_i32 s43, s43, 40960
    s_and_b32 s45, s44, 1
    s_mul_i32 s52, s45, 10240
    s_add_u32 s43, s43, s52
    s_mul_i32 s52, s45, 20480
    s_add_u32 s52, s52, 10240
    s_mov_b32 s48, 40960
    s_lshl_b32 s44, s26, 3
    s_mul_i32 s56, s44, 25600
    s_mul_i32 s54, s59, 40
    s_add_u32 s54, s54, s44
    s_lshl_b32 s54, s54, 10
    s_add_u32 s54, s54, 11534336
    s_mul_i32 s55, s60, 40
    s_add_u32 s55, s55, s44
    s_lshl_b32 s55, s55, 10
    s_add_u32 s55, s55, 11534336
    s_and_b32 s44, s26, 1
    s_mul_i32 s39, s44, 21504
    s_lshr_b32 s44, s26, 1
    s_mul_i32 s44, s44, 106496
    s_add_u32 s39, s39, s44
    s_mov_b32 s40, s39
    s_mov_b32 s45, 0x15556
    v_lshlrev_b32 v19, 4, v1
    v_lshlrev_b32 v21, 7, v1
    s_lshl_b32 s36, s26, 12
    s_min_u32 s36, s36, 11264
    v_add_u32 v20, s36, v19
    v_add_u32 v4, 0, v1
    v_mul_lo_u32 v5, v4, s45
    v_lshrrev_b32 v5, 20, v5
    v_mul_u32_u24 v6, 12, v5
    v_sub_u32 v6, v4, v6
    v_and_b32 v4, 8, v5
    v_add_u32 v5, v5, v4
    v_mul_u32_u24 v5, 1280, v5
    v_lshl_add_u32 v5, v6, 4, v5
    v_add_u32 v12, s61, v5
    v_add_u32 v4, 64, v1
    v_mul_lo_u32 v5, v4, s45
    v_lshrrev_b32 v5, 20, v5
    v_mul_u32_u24 v6, 12, v5
    v_sub_u32 v6, v4, v6
    v_and_b32 v4, 8, v5
    v_add_u32 v5, v5, v4
    v_mul_u32_u24 v5, 1280, v5
    v_lshl_add_u32 v5, v6, 4, v5
    v_add_u32 v13, s61, v5
    v_add_u32 v4, 128, v1
    v_mul_lo_u32 v5, v4, s45
    v_lshrrev_b32 v5, 20, v5
    v_mul_u32_u24 v6, 12, v5
    v_sub_u32 v6, v4, v6
    v_and_b32 v4, 8, v5
    v_add_u32 v5, v5, v4
    v_mul_u32_u24 v5, 1280, v5
    v_lshl_add_u32 v5, v6, 4, v5
    v_add_u32 v14, s61, v5
    v_bfe_u32 v4, v1, 2, 2
    v_lshl_add_u32 v4, v2, 2, v4
    v_mul_u32_u24 v4, 192, v4
    v_bfe_u32 v5, v1, 4, 1
    v_lshl_add_u32 v4, v5, 5, v4
    v_and_b32 v5, 3, v1
    v_lshl_add_u32 v4, v5, 3, v4
    v_add_u32 v4, s39, v4
    s_lshl_b32 s44, s58, 6
    s_add_u32 s45, s44, 64
    s_lshl_b32 s46, s58, 7
    s_sub_u32 s46, 128, s46
    v_add_u32 v16, s44, v4
    v_add_u32 v17, s45, v4
    v_add_u32 v18, s46, v4
    v_mov_b32 v24, 0
    v_mov_b32 v25, 0
    v_mov_b32 v26, 0
    v_mov_b32 v27, 0
    v_mov_b32 v28, 0
    v_mov_b32 v29, 0
    v_mov_b32 v30, 0
    v_mov_b32 v31, 0
    v_mov_b32 v32, 0
    v_mov_b32 v33, 0
    v_mov_b32 v34, 0
    v_mov_b32 v35, 0
    v_mov_b32 v36, 0
    v_mov_b32 v37, 0
    v_mov_b32 v38, 0
    v_mov_b32 v39, 0
    v_mov_b32 v40, 0
    v_mov_b32 v41, 0
    v_mov_b32 v42, 0
    v_mov_b32 v43, 0
    v_mov_b32 v44, 0
    v_mov_b32 v45, 0
    v_mov_b32 v46, 0
    v_mov_b32 v47, 0
    v_mov_b32 v48, 0
    v_mov_b32 v49, 0
    v_mov_b32 v50, 0
    v_mov_b32 v51, 0
    v_mov_b32 v52, 0
    v_mov_b32 v53, 0
    v_mov_b32 v54, 0
    v_mov_b32 v55, 0
    v_mov_b32 v56, 0
    v_mov_b32 v57, 0
    v_mov_b32 v58, 0
    v_mov_b32 v59, 0
    v_mov_b32 v60, 0
    v_mov_b32 v61, 0
    v_mov_b32 v62, 0
    v_mov_b32 v63, 0
    v_mov_b32 v64, 0
    v_mov_b32 v65, 0
    v_mov_b32 v66, 0
    v_mov_b32 v67, 0
    v_mov_b32 v68, 0
    v_mov_b32 v69, 0
    v_mov_b32 v70, 0
    v_mov_b32 v71, 0
    v_mov_b32 v72, 0
    v_mov_b32 v73, 0
    v_mov_b32 v74, 0
    v_mov_b32 v75, 0
    v_mov_b32 v76, 0
    v_mov_b32 v77, 0
    v_mov_b32 v78, 0
    v_mov_b32 v79, 0
    v_mov_b32 v80, 0
    v_mov_b32 v81, 0
    v_mov_b32 v82, 0
    v_mov_b32 v83, 0
    v_mov_b32 v84, 0
    v_mov_b32 v85, 0
    v_mov_b32 v86, 0
    v_mov_b32 v87, 0
    v_mov_b32 v88, 0
    v_mov_b32 v89, 0
    v_mov_b32 v90, 0
    v_mov_b32 v91, 0
    v_mov_b32 v92, 0
    v_mov_b32 v93, 0
    v_mov_b32 v94, 0
    v_mov_b32 v95, 0
    v_mov_b32 v96, 0
    v_mov_b32 v97, 0
    v_mov_b32 v98, 0
    v_mov_b32 v99, 0
    v_mov_b32 v100, 0
    v_mov_b32 v101, 0
    v_mov_b32 v102, 0
    v_mov_b32 v103, 0
    s_mov_b32 s4, s88
    s_mov_b32 s5, s89
    s_mov_b32 s6, 2211840
    s_mov_b32 s7, 0x20000
    s_lshr_b32 s44, s2, 6
    s_mul_i32 s44, s44, 552960
    s_bfe_u32 s45, s2, 0x30003
    s_lshl_b32 s45, s45, 2
    s_add_u32 s45, s45, s26
    s_mul_i32 s45, s45, 1920
    s_add_u32 s32, s44, s45
    s_mov_b32 s31, 61440
    s_lshr_b32 s45, s30, 2
    s_lshl_b32 s46, s29, 1
    s_add_u32 s45, s45, s46
    s_mul_i32 s45, s45, 108
    s_and_b32 s46, s30, 3
    s_mul_i32 s46, s46, 27
    s_add_u32 s45, s45, s46
    s_lshl_b32 s45, s45, 10
    s_mul_i32 s46, s26, 768
    s_add_u32 s45, s45, s46
    s_add_u32 s49, s45, 3072
    s_lshl_b32 s53, s29, 13
    s_add_u32 s53, s53, 15204352
    s_mov_b32 s38, 10485760
    v_mov_b32 v7, 160800
    s_cmp_lg_u32 s26, 2
    s_cbranch_scc1 opw_85
    s_mov_b32 s45, 19136512
    s_mov_b32 s44, 19144704
    s_mov_b32 s50, 4294963200
    s_mov_b32 s51, 4294967295
    s_sleep 16
    s_andn2_b64 exec, exec, s[50:51]
    s_mov_b32 s93, 400000
poll_88:
    buffer_load_dwordx2 v[8:9], v21, s[20:23], s45 offen sc1
    buffer_load_dwordx2 v[10:11], v21, s[20:23], s44 offen sc1
    s_waitcnt vmcnt(0)
    v_cmp_eq_u64 vcc, s[98:99], v[8:9]
    v_cmp_eq_u64 s[46:47], s[98:99], v[10:11]
    s_nop 1
    s_or_b64 vcc, vcc, s[50:51]
    s_or_b64 s[46:47], s[46:47], s[50:51]
    s_and_b64 vcc, vcc, s[46:47]
    s_cmp_eq_u64 vcc, -1
    s_cbranch_scc1 polld_89
    s_sub_u32 s93, s93, 1
    s_cbranch_scc1 polld_89
    s_sleep 2
    s_branch poll_88
polld_89:
    s_mov_b64 exec, -1
    v_and_b32 v8, 7, v1
    v_lshlrev_b32 v8, 2, v8
    v_add_u32 v8, 160832, v8
    s_mov_b32 s93, 3200000
cdw_90:
    ds_read_b32 v9, v8
    s_waitcnt lgkmcnt(0)
    v_cmp_eq_u32 vcc, s98, v9
    s_nop 1
    s_cmp_eq_u64 vcc, -1
    s_cbranch_scc1 cdd_91
    s_sub_u32 s93, s93, 1
    s_cbranch_scc0 cdw_90
cdd_91:
    v_mov_b32 v6, s98
    ds_write_b32 v7, v6
    s_branch opd_86
opw_85:
    s_mov_b32 s93, 3200000
ops_87:
    ds_read_b32 v6, v7
    s_waitcnt lgkmcnt(0)
    v_readfirstlane_b32 s46, v6
    s_cmp_eq_u32 s46, s98
    s_cbranch_scc1 opd_86
    s_sub_u32 s93, s93, 1
    s_cbranch_scc1 opd_86
    s_sleep 1
    s_branch ops_87
opd_86:
    s_cmp_ge_u32 s26, 2
    s_cbranch_scc1 kv3_92
    s_add_u32 m0, s36, 52224
    s_add_u32 s45, s38, 3072
    buffer_load_dwordx4 v20, s[20:23], s45 offen lds
kv3_92:
    s_add_u32 m0, s36, 49152
    s_add_u32 s45, s38, 0
    buffer_load_dwordx4 v20, s[20:23], s45 offen lds
    s_add_u32 m0, s36, 50176
    s_add_u32 s45, s38, 1024
    buffer_load_dwordx4 v20, s[20:23], s45 offen lds
    s_add_u32 m0, s36, 51200
    s_add_u32 s45, s38, 2048
    buffer_load_dwordx4 v20, s[20:23], s45 offen lds
    s_add_u32 s38, s38, 14336
    s_cmp_eq_u32 s38, 10715136
    s_cselect_b32 s38, 10485760, s38
    s_cmp_ge_u32 s26, 2
    s_cbranch_scc1 kv3_93
    s_add_u32 m0, s36, 66560
    s_add_u32 s45, s38, 3072
    buffer_load_dwordx4 v20, s[20:23], s45 offen lds
kv3_93:
    s_add_u32 m0, s36, 63488
    s_add_u32 s45, s38, 0
    buffer_load_dwordx4 v20, s[20:23], s45 offen lds
    s_add_u32 m0, s36, 64512
    s_add_u32 s45, s38, 1024
    buffer_load_dwordx4 v20, s[20:23], s45 offen lds
    s_add_u32 m0, s36, 65536
    s_add_u32 s45, s38, 2048
    buffer_load_dwordx4 v20, s[20:23], s45 offen lds
    s_add_u32 s38, s38, 14336
    s_cmp_eq_u32 s38, 10715136
    s_cselect_b32 s38, 10485760, s38
    s_cmp_ge_u32 s26, 2
    s_cbranch_scc1 kv3_94
    s_add_u32 m0, s36, 80896
    s_add_u32 s45, s38, 3072
    buffer_load_dwordx4 v20, s[20:23], s45 offen lds
kv3_94:
    s_add_u32 m0, s36, 77824
    s_add_u32 s45, s38, 0
    buffer_load_dwordx4 v20, s[20:23], s45 offen lds
    s_add_u32 m0, s36, 78848
    s_add_u32 s45, s38, 1024
    buffer_load_dwordx4 v20, s[20:23], s45 offen lds
    s_add_u32 m0, s36, 79872
    s_add_u32 s45, s38, 2048
    buffer_load_dwordx4 v20, s[20:23], s45 offen lds
    s_add_u32 s38, s38, 14336
    s_cmp_eq_u32 s38, 10715136
    s_cselect_b32 s38, 10485760, s38
    s_waitcnt vmcnt(6)
    s_barrier
    s_cmp_lg_u32 s26, 2
    s_cbranch_scc1 nokv2_95
    s_mov_b32 s45, 19136512
    s_mov_b32 s44, 19144704
    s_mov_b32 s93, 400000
poll_96:
    buffer_load_dwordx2 v[8:9], v21, s[20:23], s45 offen sc1
    buffer_load_dwordx2 v[10:11], v21, s[20:23], s44 offen sc1
    s_waitcnt vmcnt(0)
    v_cmp_eq_u64 vcc, s[98:99], v[8:9]
    v_cmp_eq_u64 s[46:47], s[98:99], v[10:11]
    s_nop 1
    s_and_b64 vcc, vcc, s[46:47]
    s_cmp_eq_u64 vcc, -1
    s_cbranch_scc1 polld_97
    s_sub_u32 s93, s93, 1
    s_cbranch_scc1 polld_97
    s_sleep 4
    s_branch poll_96
polld_97:
nokv2_95:
    s_waitcnt vmcnt(3)
    s_barrier
    s_cmp_ge_u32 s26, 2
    s_cbranch_scc1 kv3_98
    s_add_u32 m0, s36, 95232
    s_add_u32 s45, s38, 3072
    buffer_load_dwordx4 v20, s[20:23], s45 offen lds
kv3_98:
    s_add_u32 m0, s36, 92160
    s_add_u32 s45, s38, 0
    buffer_load_dwordx4 v20, s[20:23], s45 offen lds
    s_add_u32 m0, s36, 93184
    s_add_u32 s45, s38, 1024
    buffer_load_dwordx4 v20, s[20:23], s45 offen lds
    s_add_u32 m0, s36, 94208
    s_add_u32 s45, s38, 2048
    buffer_load_dwordx4 v20, s[20:23], s45 offen lds
    s_add_u32 s38, s38, 14336
    s_cmp_eq_u32 s38, 10715136
    s_cselect_b32 s38, 10485760, s38
    s_mov_b64 exec, 0x7fff
    buffer_load_dword v165, v21, s[4:7], s32 offen
    s_mov_b64 exec, -1
    s_add_u32 s32, s32, s31
    s_waitcnt vmcnt(4)
    s_barrier
    s_cmp_ge_u32 s26, 2
    s_cbranch_scc1 kv3_99
    s_add_u32 m0, s36, 52224
    s_add_u32 s45, s38, 3072
    buffer_load_dwordx4 v20, s[20:23], s45 offen lds
kv3_99:
    s_add_u32 m0, s36, 49152
    s_add_u32 s45, s38, 0
    buffer_load_dwordx4 v20, s[20:23], s45 offen lds
    s_add_u32 m0, s36, 50176
    s_add_u32 s45, s38, 1024
    buffer_load_dwordx4 v20, s[20:23], s45 offen lds
    s_add_u32 m0, s36, 51200
    s_add_u32 s45, s38, 2048
    buffer_load_dwordx4 v20, s[20:23], s45 offen lds
    s_add_u32 s38, s38, 14336
    s_cmp_eq_u32 s38, 10715136
    s_cselect_b32 s38, 10485760, s38
    s_mov_b64 exec, 0x7fff
    buffer_load_dword v165, v21, s[4:7], s32 offen
    s_mov_b64 exec, -1
    s_add_u32 s32, s32, s31
    s_waitcnt vmcnt(5)
    s_barrier
    s_cmp_lg_u32 s26, 3
    s_cbranch_scc1 noxc_100
    s_getreg_b32 s45, hwreg(HW_REG_XCC_ID, 0, 4)
    s_lshl_b32 s46, s29, 7
    s_add_u32 s46, s46, 19234816
    v_and_b32 v4, 7, v1
    v_lshlrev_b32 v4, 3, v4
    buffer_load_dwordx2 v[8:9], v4, s[20:23], s46 offen sc1
    s_mov_b32 s44, s98
    s_waitcnt vmcnt(0)
    v_cmp_eq_u64 vcc, s[44:45], v[8:9]
    v_mov_b32 v4, 160928
    s_nop 0
    s_cmp_eq_u64 vcc, -1
    s_cselect_b32 s44, s98, 0
    v_mov_b32 v5, s44
    ds_write_b32 v4, v5
    s_waitcnt lgkmcnt(0)
noxc_100:
    s_cmp_ge_u32 s26, 2
    s_cbranch_scc1 kv3_101
    s_add_u32 m0, s36, 66560
    s_add_u32 s45, s38, 3072
    buffer_load_dwordx4 v20, s[20:23], s45 offen lds
kv3_101:
    s_add_u32 m0, s36, 63488
    s_add_u32 s45, s38, 0
    buffer_load_dwordx4 v20, s[20:23], s45 offen lds
    s_add_u32 m0, s36, 64512
    s_add_u32 s45, s38, 1024
    buffer_load_dwordx4 v20, s[20:23], s45 offen lds
    s_add_u32 m0, s36, 65536
    s_add_u32 s45, s38, 2048
    buffer_load_dwordx4 v20, s[20:23], s45 offen lds
    s_add_u32 s38, s38, 14336
    s_cmp_eq_u32 s38, 10715136
    s_cselect_b32 s38, 10485760, s38
    s_add_u32 m0, s39, 0
    s_nop 0
    buffer_load_dwordx4 v12, s[12:15], s43 offen lds
    s_add_u32 m0, s39, 1024
    s_nop 0
    buffer_load_dwordx4 v13, s[12:15], s43 offen lds
    s_add_u32 m0, s39, 2048
    s_nop 0
    buffer_load_dwordx4 v14, s[12:15], s43 offen lds
    s_add_u32 s43, s43, s52
    s_sub_u32 s52, s48, s52
    s_add_u32 m0, s39, 3072
    s_nop 0
    buffer_load_dwordx4 v12, s[12:15], s43 offen lds
    s_add_u32 m0, s39, 4096
    s_nop 0
    buffer_load_dwordx4 v13, s[12:15], s43 offen lds
    s_add_u32 m0, s39, 5120
    s_nop 0
    buffer_load_dwordx4 v14, s[12:15], s43 offen lds
    s_add_u32 s43, s43, s52
    s_sub_u32 s52, s48, s52
    s_add_u32 m0, s39, 6144
    s_nop 0
    buffer_load_dwordx4 v12, s[12:15], s43 offen lds
    s_add_u32 m0, s39, 7168
    s_nop 0
    buffer_load_dwordx4 v13, s[12:15], s43 offen lds
    s_add_u32 m0, s39, 8192
    s_nop 0
    buffer_load_dwordx4 v14, s[12:15], s43 offen lds
    s_add_u32 s43, s43, s52
    s_sub_u32 s52, s48, s52
    s_mov_b64 exec, 0x7fff
    buffer_load_dword v165, v21, s[4:7], s32 offen
    s_mov_b64 exec, -1
    s_add_u32 s32, s32, s31
    s_waitcnt vmcnt(14)
    s_barrier
    s_cmp_ge_u32 s26, 2
    s_cbranch_scc1 kv3_102
    s_add_u32 m0, s36, 80896
    s_add_u32 s45, s38, 3072
    buffer_load_dwordx4 v20, s[20:23], s45 offen lds
kv3_102:
    s_add_u32 m0, s36, 77824
    s_add_u32 s45, s38, 0
    buffer_load_dwordx4 v20, s[20:23], s45 offen lds
    s_add_u32 m0, s36, 78848
    s_add_u32 s45, s38, 1024
    buffer_load_dwordx4 v20, s[20:23], s45 offen lds
    s_add_u32 m0, s36, 79872
    s_add_u32 s45, s38, 2048
    buffer_load_dwordx4 v20, s[20:23], s45 offen lds
    s_add_u32 s38, s38, 14336
    s_cmp_eq_u32 s38, 10715136
    s_cselect_b32 s38, 10485760, s38
    s_add_u32 m0, s39, 9216
    s_nop 0
    buffer_load_dwordx4 v12, s[12:15], s43 offen lds
    s_add_u32 m0, s39, 10240
    s_nop 0
    buffer_load_dwordx4 v13, s[12:15], s43 offen lds
    s_add_u32 m0, s39, 11264
    s_nop 0
    buffer_load_dwordx4 v14, s[12:15], s43 offen lds
    s_add_u32 s43, s43, s52
    s_sub_u32 s52, s48, s52
    s_add_u32 m0, s39, 12288
    s_nop 0
    buffer_load_dwordx4 v12, s[12:15], s43 offen lds
    s_add_u32 m0, s39, 13312
    s_nop 0
    buffer_load_dwordx4 v13, s[12:15], s43 offen lds
    s_add_u32 m0, s39, 14336
    s_nop 0
    buffer_load_dwordx4 v14, s[12:15], s43 offen lds
    s_add_u32 s43, s43, s52
    s_sub_u32 s52, s48, s52
    s_add_u32 m0, s39, 15360
    s_nop 0
    buffer_load_dwordx4 v12, s[12:15], s43 offen lds
    s_add_u32 m0, s39, 16384
    s_nop 0
    buffer_load_dwordx4 v13, s[12:15], s43 offen lds
    s_add_u32 m0, s39, 17408
    s_nop 0
    buffer_load_dwordx4 v14, s[12:15], s43 offen lds
    s_add_u32 s43, s43, s52
    s_sub_u32 s52, s48, s52
    s_mov_b64 exec, 0x7fff
    buffer_load_dword v165, v21, s[4:7], s32 offen
    s_mov_b64 exec, -1
    s_add_u32 s32, s32, s31
    s_mov_b32 s34, 12
    s_mov_b32 s35, 0
    s_mov_b32 s37, 43008
    s_mov_b32 s33, 9216
    s_mov_b32 s93, 400000
    v_mov_b32 v7, 160804
dtop_103:
    s_sub_u32 s44, s35, 2
    s_cmp_lt_u32 s44, 7
    s_cselect_b32 s45, s34, 0
    s_cmp_gt_u32 s45, 3
    s_cbranch_scc1 dfast_118
    s_cmp_lt_u32 s44, 8
    s_cbranch_scc1 dact_107
    s_cmp_eq_u32 s35, 11
    s_cbranch_scc1 dw2_119
    s_cmp_gt_u32 s35, 1
    s_cbranch_scc1 dw0_115
    s_cmp_le_u32 s34, 3
    s_cbranch_scc1 dw0_115
    s_cmp_eq_u32 s35, 1
    s_cbranch_scc1 dw1_125
    s_waitcnt vmcnt(3)
    s_branch dbar_108
dw1_125:
    s_waitcnt vmcnt(9)
    s_branch df1_116
dw2_119:
    s_waitcnt vmcnt(12)
    s_mov_b32 s35, 12
    s_branch dbar_108
dw0_115:
    s_waitcnt vmcnt(0)
    s_branch dbar_108
dact_107:
    s_waitcnt vmcnt(16)
dbar_108:
    s_cmp_eq_u32 s34, 0
    s_cbranch_scc1 dnb_104
    s_barrier
    s_cmp_lg_u32 s35, 0
    s_cbranch_scc1 dnp_122
    s_cmp_lg_u32 s26, 3
    s_cbranch_scc1 dnp_122
    buffer_load_dwordx2 v[8:9], v21, s[20:23], s53 offen sc1
dnp_122:
    s_cmp_le_u32 s34, 3
    s_cbranch_scc1 dnokv_109
    s_add_u32 s44, s36, s37
    s_cmp_ge_u32 s26, 2
    s_cbranch_scc1 dk3_124
    s_add_u32 m0, s44, 52224
    s_add_u32 s45, s38, 3072
    buffer_load_dwordx4 v20, s[20:23], s45 offen lds
dk3_124:
    s_add_u32 m0, s44, 49152
    s_add_u32 s45, s38, 0
    buffer_load_dwordx4 v20, s[20:23], s45 offen lds
    s_add_u32 m0, s44, 50176
    s_add_u32 s45, s38, 1024
    buffer_load_dwordx4 v20, s[20:23], s45 offen lds
    s_add_u32 m0, s44, 51200
    s_add_u32 s45, s38, 2048
    buffer_load_dwordx4 v20, s[20:23], s45 offen lds
    s_add_u32 s38, s38, 14336
    s_cmp_eq_u32 s38, 10715136
    s_cselect_b32 s38, 10485760, s38
    s_add_u32 s37, s37, 14336
    s_cmp_eq_u32 s37, 57344
    s_cselect_b32 s37, 0, s37
dnokv_109:
    s_sub_u32 s34, s34, 1
    s_branch dsw_105
dnb_104:
    s_cmp_ge_u32 s35, 11
    s_cbranch_scc1 dend_106
dsw_105:
    s_cmp_eq_u32 s35, 0
    s_cbranch_scc1 ds0_110
    s_cmp_lt_u32 s35, 9
    s_cbranch_scc1 dbody_111
    s_cmp_eq_u32 s35, 9
    s_cbranch_scc1 dlast_112
    s_cmp_eq_u32 s35, 10
    s_cbranch_scc1 dwo_113
    s_branch dtop_103
ds0_110:
    s_sub_u32 s93, s93, 1
    s_cbranch_scc1 dstart_128
    s_cmp_lg_u32 s26, 3
    s_cbranch_scc1 doth_127
    s_cmp_ge_u32 s34, 3
    s_cbranch_scc1 dp3_123
    buffer_load_dwordx2 v[8:9], v21, s[20:23], s53 offen sc1
    s_waitcnt vmcnt(0)
dp3_123:
    s_waitcnt vmcnt(3)
    v_cmp_eq_u64 vcc, s[98:99], v[8:9]
    s_lshl_b32 s45, s34, 1
    s_nop 0
    s_cmp_eq_u64 vcc, -1
    s_cselect_b32 s44, s98, s45
    v_mov_b32 v6, s44
    ds_write_b32 v7, v6
    s_cbranch_scc1 dstart_128
    s_branch dtop_103
doth_127:
    s_mov_b32 s45, 40
drei_129:
    s_sleep 1
    ds_read_b32 v6, v7
    s_waitcnt lgkmcnt(0)
    v_readfirstlane_b32 s44, v6
    s_cmp_eq_u32 s44, s98
    s_cbranch_scc1 dstart_128
    s_lshl_b32 s46, s34, 1
    s_cmp_eq_u32 s44, s46
    s_cbranch_scc1 dtop_103
    s_sub_u32 s45, s45, 1
    s_cbranch_scc0 drei_129
    s_branch dtop_103
dstart_128:
    buffer_load_dwordx4 v[116:119], v19, s[20:23], s41 offen
    s_add_u32 s41, s41, 1024
    buffer_load_dwordx4 v[120:123], v19, s[20:23], s42 offen
    s_add_u32 s42, s42, 1024
    buffer_load_dwordx4 v[136:139], v19, s[20:23], s41 offen
    s_add_u32 s41, s41, 1024
    buffer_load_dwordx4 v[140:143], v19, s[20:23], s42 offen
    s_add_u32 s42, s42, 1024
    buffer_load_dwordx4 v[156:159], v19, s[20:23], s41 offen
    s_add_u32 s41, s41, 1024
    buffer_load_dwordx4 v[160:163], v19, s[20:23], s42 offen
    s_add_u32 s42, s42, 1024
    ds_read_b64_tr_b16 v[104:105], v16 offset:0
    ds_read_b64_tr_b16 v[106:107], v16 offset:1536
    ds_read_b64_tr_b16 v[108:109], v17 offset:0
    ds_read_b64_tr_b16 v[110:111], v17 offset:1536
    ds_read_b64_tr_b16 v[112:113], v18 offset:0
    ds_read_b64_tr_b16 v[114:115], v18 offset:1536
dnext_114:
    s_add_u32 s35, s35, 1
    s_branch dtop_103
dbody_111:
    s_cmp_lg_u32 s35, 1
    s_cbranch_scc1 dn1_126
    s_waitcnt vmcnt(0)
dn1_126:
    s_cmp_lg_u32 s35, 8
    s_cbranch_scc1 dnsw_131
    s_mov_b32 s12, s16
    s_mov_b32 s13, s17
    s_mov_b32 s14, 819200
    s_mov_b32 s43, s56
    s_mov_b32 s52, 25600
    s_mov_b32 s48, 51200
    s_mov_b32 s45, 0x15556
    v_add_u32 v4, 0, v1
    v_mul_lo_u32 v5, v4, s45
    v_lshrrev_b32 v5, 23, v5
    v_mul_u32_u24 v5, 10240, v5
    v_sub_u32 v12, v12, v5
    v_add_u32 v4, 64, v1
    v_mul_lo_u32 v5, v4, s45
    v_lshrrev_b32 v5, 23, v5
    v_mul_u32_u24 v5, 10240, v5
    v_sub_u32 v13, v13, v5
    v_add_u32 v4, 128, v1
    v_mul_lo_u32 v5, v4, s45
    v_lshrrev_b32 v5, 23, v5
    v_mul_u32_u24 v5, 10240, v5
    v_sub_u32 v14, v14, v5
dnsw_131:
    s_cmp_lt_u32 s34, 3
    s_cbranch_scc1 db12_120
    s_waitcnt vmcnt(14) lgkmcnt(0)
    s_setprio 0
    v_mfma_f32_32x32x16_bf16 v[24:39], v[104:107], v[116:119], v[24:39]
    ds_read_b64_tr_b16 v[124:125], v16 offset:3072
    ds_read_b64_tr_b16 v[126:127], v16 offset:4608
    s_add_u32 m0, s40, 0
    s_nop 0
    buffer_load_dwordx4 v12, s[12:15], s43 offen lds
    v_mfma_f32_32x32x16_bf16 v[40:55], v[104:107], v[120:123], v[40:55]
    ds_read_b64_tr_b16 v[128:129], v17 offset:3072
    ds_read_b64_tr_b16 v[130:131], v17 offset:4608
    s_add_u32 m0, s40, 1024
    s_nop 0
    buffer_load_dwordx4 v13, s[12:15], s43 offen lds
    v_mfma_f32_32x32x16_bf16 v[72:87], v[108:111], v[120:123], v[72:87]
    ds_read_b64_tr_b16 v[132:133], v18 offset:3072
    ds_read_b64_tr_b16 v[134:135], v18 offset:4608
    s_add_u32 m0, s40, 2048
    s_nop 0
    buffer_load_dwordx4 v14, s[12:15], s43 offen lds
    s_add_u32 s43, s43, s52
    s_sub_u32 s52, s48, s52
    v_mfma_f32_32x32x16_bf16 v[56:71], v[108:111], v[116:119], v[56:71]
    buffer_load_dwordx4 v[120:123], v19, s[20:23], s42 offen
    s_add_u32 s42, s42, 1024
    v_mfma_f32_32x32x16_bf16 v[88:103], v[112:115], v[116:119], v[88:103]
    buffer_load_dwordx4 v[116:119], v19, s[20:23], s41 offen
    s_add_u32 s41, s41, 1024
    s_waitcnt vmcnt(14) lgkmcnt(0)
    s_setprio 0
    v_mfma_f32_32x32x16_bf16 v[24:39], v[124:127], v[136:139], v[24:39]
    ds_read_b64_tr_b16 v[144:145], v16 offset:6144
    ds_read_b64_tr_b16 v[146:147], v16 offset:7680
    s_add_u32 m0, s40, 3072
    s_nop 0
    buffer_load_dwordx4 v12, s[12:15], s43 offen lds
    v_mfma_f32_32x32x16_bf16 v[40:55], v[124:127], v[140:143], v[40:55]
    ds_read_b64_tr_b16 v[148:149], v17 offset:6144
    ds_read_b64_tr_b16 v[150:151], v17 offset:7680
    s_add_u32 m0, s40, 4096
    s_nop 0
    buffer_load_dwordx4 v13, s[12:15], s43 offen lds
    v_mfma_f32_32x32x16_bf16 v[72:87], v[128:131], v[140:143], v[72:87]
    ds_read_b64_tr_b16 v[152:153], v18 offset:6144
    ds_read_b64_tr_b16 v[154:155], v18 offset:7680
    s_add_u32 m0, s40, 5120
    s_nop 0
    buffer_load_dwordx4 v14, s[12:15], s43 offen lds
    s_add_u32 s43, s43, s52
    s_sub_u32 s52, s48, s52
    v_mfma_f32_32x32x16_bf16 v[56:71], v[128:131], v[136:139], v[56:71]
    buffer_load_dwordx4 v[140:143], v19, s[20:23], s42 offen
    s_add_u32 s42, s42, 1024
    v_mfma_f32_32x32x16_bf16 v[88:103], v[132:135], v[136:139], v[88:103]
    buffer_load_dwordx4 v[136:139], v19, s[20:23], s41 offen
    s_add_u32 s41, s41, 1024
    s_waitcnt vmcnt(14) lgkmcnt(0)
    s_setprio 3
    v_add_u32 v16, s33, v16
    v_add_u32 v17, s33, v17
    v_add_u32 v18, s33, v18
    s_setprio 0
    v_mfma_f32_32x32x16_bf16 v[24:39], v[144:147], v[156:159], v[24:39]
    ds_read_b64_tr_b16 v[104:105], v16 offset:0
    ds_read_b64_tr_b16 v[106:107], v16 offset:1536
    s_add_u32 m0, s40, 6144
    s_nop 0
    buffer_load_dwordx4 v12, s[12:15], s43 offen lds
    v_mfma_f32_32x32x16_bf16 v[40:55], v[144:147], v[160:163], v[40:55]
    ds_read_b64_tr_b16 v[108:109], v17 offset:0
    ds_read_b64_tr_b16 v[110:111], v17 offset:1536
    s_add_u32 m0, s40, 7168
    s_nop 0
    buffer_load_dwordx4 v13, s[12:15], s43 offen lds
    v_mfma_f32_32x32x16_bf16 v[72:87], v[148:151], v[160:163], v[72:87]
    ds_read_b64_tr_b16 v[112:113], v18 offset:0
    ds_read_b64_tr_b16 v[114:115], v18 offset:1536
    s_add_u32 m0, s40, 8192
    s_nop 0
    buffer_load_dwordx4 v14, s[12:15], s43 offen lds
    s_add_u32 s43, s43, s52
    s_sub_u32 s52, s48, s52
    v_mfma_f32_32x32x16_bf16 v[56:71], v[148:151], v[156:159], v[56:71]
    buffer_load_dwordx4 v[160:163], v19, s[20:23], s42 offen
    s_add_u32 s42, s42, 1024
    v_mfma_f32_32x32x16_bf16 v[88:103], v[152:155], v[156:159], v[88:103]
    buffer_load_dwordx4 v[156:159], v19, s[20:23], s41 offen
    s_add_u32 s41, s41, 1024
    s_setprio 3
    s_add_u32 s40, s40, s33
    s_sub_u32 s33, 0, s33
    s_branch dbd_121
db12_120:
    s_waitcnt vmcnt(11) lgkmcnt(0)
    s_setprio 0
    v_mfma_f32_32x32x16_bf16 v[24:39], v[104:107], v[116:119], v[24:39]
    ds_read_b64_tr_b16 v[124:125], v16 offset:3072
    ds_read_b64_tr_b16 v[126:127], v16 offset:4608
    s_add_u32 m0, s40, 0
    s_nop 0
    buffer_load_dwordx4 v12, s[12:15], s43 offen lds
    v_mfma_f32_32x32x16_bf16 v[40:55], v[104:107], v[120:123], v[40:55]
    ds_read_b64_tr_b16 v[128:129], v17 offset:3072
    ds_read_b64_tr_b16 v[130:131], v17 offset:4608
    s_add_u32 m0, s40, 1024
    s_nop 0
    buffer_load_dwordx4 v13, s[12:15], s43 offen lds
    v_mfma_f32_32x32x16_bf16 v[72:87], v[108:111], v[120:123], v[72:87]
    ds_read_b64_tr_b16 v[132:133], v18 offset:3072
    ds_read_b64_tr_b16 v[134:135], v18 offset:4608
    s_add_u32 m0, s40, 2048
    s_nop 0
    buffer_load_dwordx4 v14, s[12:15], s43 offen lds
    s_add_u32 s43, s43, s52
    s_sub_u32 s52, s48, s52
    v_mfma_f32_32x32x16_bf16 v[56:71], v[108:111], v[116:119], v[56:71]
    buffer_load_dwordx4 v[120:123], v19, s[20:23], s42 offen
    s_add_u32 s42, s42, 1024
    v_mfma_f32_32x32x16_bf16 v[88:103], v[112:115], v[116:119], v[88:103]
    buffer_load_dwordx4 v[116:119], v19, s[20:23], s41 offen
    s_add_u32 s41, s41, 1024
    s_waitcnt vmcnt(11) lgkmcnt(0)
    s_setprio 0
    v_mfma_f32_32x32x16_bf16 v[24:39], v[124:127], v[136:139], v[24:39]
    ds_read_b64_tr_b16 v[144:145], v16 offset:6144
    ds_read_b64_tr_b16 v[146:147], v16 offset:7680
    s_add_u32 m0, s40, 3072
    s_nop 0
    buffer_load_dwordx4 v12, s[12:15], s43 offen lds
    v_mfma_f32_32x32x16_bf16 v[40:55], v[124:127], v[140:143], v[40:55]
    ds_read_b64_tr_b16 v[148:149], v17 offset:6144
    ds_read_b64_tr_b16 v[150:151], v17 offset:7680
    s_add_u32 m0, s40, 4096
    s_nop 0
    buffer_load_dwordx4 v13, s[12:15], s43 offen lds
    v_mfma_f32_32x32x16_bf16 v[72:87], v[128:131], v[140:143], v[72:87]
    ds_read_b64_tr_b16 v[152:153], v18 offset:6144
    ds_read_b64_tr_b16 v[154:155], v18 offset:7680
    s_add_u32 m0, s40, 5120
    s_nop 0
    buffer_load_dwordx4 v14, s[12:15], s43 offen lds
    s_add_u32 s43, s43, s52
    s_sub_u32 s52, s48, s52
    v_mfma_f32_32x32x16_bf16 v[56:71], v[128:131], v[136:139], v[56:71]
    buffer_load_dwordx4 v[140:143], v19, s[20:23], s42 offen
    s_add_u32 s42, s42, 1024
    v_mfma_f32_32x32x16_bf16 v[88:103], v[132:135], v[136:139], v[88:103]
    buffer_load_dwordx4 v[136:139], v19, s[20:23], s41 offen
    s_add_u32 s41, s41, 1024
    s_waitcnt vmcnt(11) lgkmcnt(0)
    s_setprio 3
    v_add_u32 v16, s33, v16
    v_add_u32 v17, s33, v17
    v_add_u32 v18, s33, v18
    s_setprio 0
    v_mfma_f32_32x32x16_bf16 v[24:39], v[144:147], v[156:159], v[24:39]
    ds_read_b64_tr_b16 v[104:105], v16 offset:0
    ds_read_b64_tr_b16 v[106:107], v16 offset:1536
    s_add_u32 m0, s40, 6144
    s_nop 0
    buffer_load_dwordx4 v12, s[12:15], s43 offen lds
    v_mfma_f32_32x32x16_bf16 v[40:55], v[144:147], v[160:163], v[40:55]
    ds_read_b64_tr_b16 v[108:109], v17 offset:0
    ds_read_b64_tr_b16 v[110:111], v17 offset:1536
    s_add_u32 m0, s40, 7168
    s_nop 0
    buffer_load_dwordx4 v13, s[12:15], s43 offen lds
    v_mfma_f32_32x32x16_bf16 v[72:87], v[148:151], v[160:163], v[72:87]
    ds_read_b64_tr_b16 v[112:113], v18 offset:0
    ds_read_b64_tr_b16 v[114:115], v18 offset:1536
    s_add_u32 m0, s40, 8192
    s_nop 0
    buffer_load_dwordx4 v14, s[12:15], s43 offen lds
    s_add_u32 s43, s43, s52
    s_sub_u32 s52, s48, s52
    v_mfma_f32_32x32x16_bf16 v[56:71], v[148:151], v[156:159], v[56:71]
    buffer_load_dwordx4 v[160:163], v19, s[20:23], s42 offen
    s_add_u32 s42, s42, 1024
    v_mfma_f32_32x32x16_bf16 v[88:103], v[152:155], v[156:159], v[88:103]
    buffer_load_dwordx4 v[156:159], v19, s[20:23], s41 offen
    s_add_u32 s41, s41, 1024
    s_setprio 3
    s_add_u32 s40, s40, s33
    s_sub_u32 s33, 0, s33
dbd_121:
    s_cmp_lg_u32 s35, 6
    s_cbranch_scc1 npsw_132
    s_mov_b32 s4, s16
    s_mov_b32 s5, s17
    s_mov_b32 s6, 819200
    s_lshr_b32 s44, s2, 3
    s_lshl_b32 s44, s44, 2
    s_add_u32 s44, s44, s26
    s_mul_i32 s32, s44, 6400
    s_mov_b32 s31, 1664
npsw_132:
    s_mov_b64 exec, 0x7fff
    buffer_load_dword v165, v21, s[4:7], s32 offen
    s_mov_b64 exec, -1
    s_add_u32 s32, s32, s31
    s_branch dnext_114
dlast_112:
    s_waitcnt vmcnt(11) lgkmcnt(0)
    s_setprio 0
    v_mfma_f32_32x32x16_bf16 v[24:39], v[104:107], v[116:119], v[24:39]
    ds_read_b64_tr_b16 v[124:125], v16 offset:3072
    ds_read_b64_tr_b16 v[126:127], v16 offset:4608
    s_add_u32 m0, s40, 0
    s_nop 0
    buffer_load_dwordx4 v12, s[12:15], s43 offen lds
    v_mfma_f32_32x32x16_bf16 v[40:55], v[104:107], v[120:123], v[40:55]
    ds_read_b64_tr_b16 v[128:129], v17 offset:3072
    ds_read_b64_tr_b16 v[130:131], v17 offset:4608
    s_add_u32 m0, s40, 1024
    s_nop 0
    buffer_load_dwordx4 v13, s[12:15], s43 offen lds
    v_mfma_f32_32x32x16_bf16 v[72:87], v[108:111], v[120:123], v[72:87]
    ds_read_b64_tr_b16 v[132:133], v18 offset:3072
    ds_read_b64_tr_b16 v[134:135], v18 offset:4608
    s_add_u32 m0, s40, 2048
    s_nop 0
    buffer_load_dwordx4 v14, s[12:15], s43 offen lds
    s_add_u32 s43, s43, s52
    s_sub_u32 s52, s48, s52
    v_mfma_f32_32x32x16_bf16 v[56:71], v[108:111], v[116:119], v[56:71]
    v_mfma_f32_32x32x16_bf16 v[88:103], v[112:115], v[116:119], v[88:103]
    s_waitcnt vmcnt(9) lgkmcnt(0)
    s_setprio 0
    v_mfma_f32_32x32x16_bf16 v[24:39], v[124:127], v[136:139], v[24:39]
    ds_read_b64_tr_b16 v[144:145], v16 offset:6144
    ds_read_b64_tr_b16 v[146:147], v16 offset:7680
    s_add_u32 m0, s40, 3072
    s_nop 0
    buffer_load_dwordx4 v12, s[12:15], s43 offen lds
    v_mfma_f32_32x32x16_bf16 v[40:55], v[124:127], v[140:143], v[40:55]
    ds_read_b64_tr_b16 v[148:149], v17 offset:6144
    ds_read_b64_tr_b16 v[150:151], v17 offset:7680
    s_add_u32 m0, s40, 4096
    s_nop 0
    buffer_load_dwordx4 v13, s[12:15], s43 offen lds
    v_mfma_f32_32x32x16_bf16 v[72:87], v[128:131], v[140:143], v[72:87]
    ds_read_b64_tr_b16 v[152:153], v18 offset:6144
    ds_read_b64_tr_b16 v[154:155], v18 offset:7680
    s_add_u32 m0, s40, 5120
    s_nop 0
    buffer_load_dwordx4 v14, s[12:15], s43 offen lds
    s_add_u32 s43, s43, s52
    s_sub_u32 s52, s48, s52
    v_mfma_f32_32x32x16_bf16 v[56:71], v[128:131], v[136:139], v[56:71]
    v_mfma_f32_32x32x16_bf16 v[88:103], v[132:135], v[136:139], v[88:103]
    s_waitcnt vmcnt(7) lgkmcnt(0)
    s_setprio 3
    v_add_u32 v16, s33, v16
    v_add_u32 v17, s33, v17
    v_add_u32 v18, s33, v18
    s_setprio 0
    v_mfma_f32_32x32x16_bf16 v[24:39], v[144:147], v[156:159], v[24:39]
    ds_read_b64_tr_b16 v[104:105], v16 offset:0
    ds_read_b64_tr_b16 v[106:107], v16 offset:1536
    s_add_u32 m0, s40, 6144
    s_nop 0
    buffer_load_dwordx4 v12, s[12:15], s43 offen lds
    v_mfma_f32_32x32x16_bf16 v[40:55], v[144:147], v[160:163], v[40:55]
    ds_read_b64_tr_b16 v[108:109], v17 offset:0
    ds_read_b64_tr_b16 v[110:111], v17 offset:1536
    s_add_u32 m0, s40, 7168
    s_nop 0
    buffer_load_dwordx4 v13, s[12:15], s43 offen lds
    v_mfma_f32_32x32x16_bf16 v[72:87], v[148:151], v[160:163], v[72:87]
    ds_read_b64_tr_b16 v[112:113], v18 offset:0
    ds_read_b64_tr_b16 v[114:115], v18 offset:1536
    s_add_u32 m0, s40, 8192
    s_nop 0
    buffer_load_dwordx4 v14, s[12:15], s43 offen lds
    s_add_u32 s43, s43, s52
    s_sub_u32 s52, s48, s52
    v_mfma_f32_32x32x16_bf16 v[56:71], v[148:151], v[156:159], v[56:71]
    v_mfma_f32_32x32x16_bf16 v[88:103], v[152:155], v[156:159], v[88:103]
    s_setprio 3
    s_add_u32 s40, s40, s33
    s_sub_u32 s33, 0, s33
    s_branch dnext_114
df1_116:
    s_barrier
    s_waitcnt vmcnt(0)
    s_branch df2_117
fws_133:
    s_cmp_lg_u32 s35, 8
    s_cbranch_scc1 dnsw_137
    s_mov_b32 s12, s16
    s_mov_b32 s13, s17
    s_mov_b32 s14, 819200
    s_mov_b32 s43, s56
    s_mov_b32 s52, 25600
    s_mov_b32 s48, 51200
    s_mov_b32 s45, 0x15556
    v_add_u32 v4, 0, v1
    v_mul_lo_u32 v5, v4, s45
    v_lshrrev_b32 v5, 23, v5
    v_mul_u32_u24 v5, 10240, v5
    v_sub_u32 v12, v12, v5
    v_add_u32 v4, 64, v1
    v_mul_lo_u32 v5, v4, s45
    v_lshrrev_b32 v5, 23, v5
    v_mul_u32_u24 v5, 10240, v5
    v_sub_u32 v13, v13, v5
    v_add_u32 v4, 128, v1
    v_mul_lo_u32 v5, v4, s45
    v_lshrrev_b32 v5, 23, v5
    v_mul_u32_u24 v5, 10240, v5
    v_sub_u32 v14, v14, v5
dnsw_137:
    s_branch fwsb_134
fps_135:
    s_cmp_lg_u32 s35, 6
    s_cbranch_scc1 npsw_138
    s_mov_b32 s4, s16
    s_mov_b32 s5, s17
    s_mov_b32 s6, 819200
    s_lshr_b32 s44, s2, 3
    s_lshl_b32 s44, s44, 2
    s_add_u32 s44, s44, s26
    s_mul_i32 s32, s44, 6400
    s_mov_b32 s31, 1664
npsw_138:
    s_branch fpsb_136
dfast_118:
    s_cmp_eq_u32 s35, 8
    s_cbranch_scc1 fws_133
fwsb_134:
    s_barrier
df2_117:
    s_waitcnt vmcnt(11) lgkmcnt(0)
    s_setprio 0
    v_mfma_f32_32x32x16_bf16 v[24:39], v[104:107], v[116:119], v[24:39]
    ds_read_b64_tr_b16 v[124:125], v16 offset:3072
    ds_read_b64_tr_b16 v[126:127], v16 offset:4608
    s_add_u32 m0, s40, 0
    s_nop 0
    buffer_load_dwordx4 v12, s[12:15], s43 offen lds
    v_mfma_f32_32x32x16_bf16 v[40:55], v[104:107], v[120:123], v[40:55]
    ds_read_b64_tr_b16 v[128:129], v17 offset:3072
    ds_read_b64_tr_b16 v[130:131], v17 offset:4608
    s_add_u32 m0, s40, 1024
    s_nop 0
    buffer_load_dwordx4 v13, s[12:15], s43 offen lds
    v_mfma_f32_32x32x16_bf16 v[72:87], v[108:111], v[120:123], v[72:87]
    ds_read_b64_tr_b16 v[132:133], v18 offset:3072
    ds_read_b64_tr_b16 v[134:135], v18 offset:4608
    s_add_u32 m0, s40, 2048
    s_nop 0
    buffer_load_dwordx4 v14, s[12:15], s43 offen lds
    s_add_u32 s43, s43, s52
    s_sub_u32 s52, s48, s52
    v_mfma_f32_32x32x16_bf16 v[56:71], v[108:111], v[116:119], v[56:71]
    buffer_load_dwordx4 v[120:123], v19, s[20:23], s42 offen
    s_add_u32 s42, s42, 1024
    s_add_u32 s44, s36, s37
    s_add_u32 m0, s44, 49152
    s_add_u32 s45, s38, 0
    buffer_load_dwordx4 v20, s[20:23], s45 offen lds
    v_mfma_f32_32x32x16_bf16 v[88:103], v[112:115], v[116:119], v[88:103]
    buffer_load_dwordx4 v[116:119], v19, s[20:23], s41 offen
    s_add_u32 s41, s41, 1024
    s_add_u32 s44, s36, s37
    s_add_u32 m0, s44, 50176
    s_add_u32 s45, s38, 1024
    buffer_load_dwordx4 v20, s[20:23], s45 offen lds
    s_waitcnt vmcnt(13) lgkmcnt(0)
    s_setprio 0
    v_mfma_f32_32x32x16_bf16 v[24:39], v[124:127], v[136:139], v[24:39]
    ds_read_b64_tr_b16 v[144:145], v16 offset:6144
    ds_read_b64_tr_b16 v[146:147], v16 offset:7680
    s_add_u32 m0, s40, 3072
    s_nop 0
    buffer_load_dwordx4 v12, s[12:15], s43 offen lds
    v_mfma_f32_32x32x16_bf16 v[40:55], v[124:127], v[140:143], v[40:55]
    ds_read_b64_tr_b16 v[148:149], v17 offset:6144
    ds_read_b64_tr_b16 v[150:151], v17 offset:7680
    s_add_u32 m0, s40, 4096
    s_nop 0
    buffer_load_dwordx4 v13, s[12:15], s43 offen lds
    v_mfma_f32_32x32x16_bf16 v[72:87], v[128:131], v[140:143], v[72:87]
    ds_read_b64_tr_b16 v[152:153], v18 offset:6144
    ds_read_b64_tr_b16 v[154:155], v18 offset:7680
    s_add_u32 m0, s40, 5120
    s_nop 0
    buffer_load_dwordx4 v14, s[12:15], s43 offen lds
    s_add_u32 s43, s43, s52
    s_sub_u32 s52, s48, s52
    v_mfma_f32_32x32x16_bf16 v[56:71], v[128:131], v[136:139], v[56:71]
    buffer_load_dwordx4 v[140:143], v19, s[20:23], s42 offen
    s_add_u32 s42, s42, 1024
    s_add_u32 s44, s36, s37
    s_add_u32 m0, s44, 51200
    s_add_u32 s45, s38, 2048
    buffer_load_dwordx4 v20, s[20:23], s45 offen lds
    v_mfma_f32_32x32x16_bf16 v[88:103], v[132:135], v[136:139], v[88:103]
    buffer_load_dwordx4 v[136:139], v19, s[20:23], s41 offen
    s_add_u32 s41, s41, 1024
    s_cmp_ge_u32 s26, 2
    s_cbranch_scc1 fk3_139
    s_add_u32 s44, s36, s37
    s_add_u32 m0, s44, 52224
    s_add_u32 s45, s38, 3072
    buffer_load_dwordx4 v20, s[20:23], s45 offen lds
fk3_139:
    s_add_u32 s38, s38, 14336
    s_cmp_eq_u32 s38, 10715136
    s_cselect_b32 s38, 10485760, s38
    s_add_u32 s37, s37, 14336
    s_cmp_eq_u32 s37, 57344
    s_cselect_b32 s37, 0, s37
    s_waitcnt vmcnt(14) lgkmcnt(0)
    s_setprio 3
    v_add_u32 v16, s33, v16
    v_add_u32 v17, s33, v17
    v_add_u32 v18, s33, v18
    s_setprio 0
    v_mfma_f32_32x32x16_bf16 v[24:39], v[144:147], v[156:159], v[24:39]
    ds_read_b64_tr_b16 v[104:105], v16 offset:0
    ds_read_b64_tr_b16 v[106:107], v16 offset:1536
    s_add_u32 m0, s40, 6144
    s_nop 0
    buffer_load_dwordx4 v12, s[12:15], s43 offen lds
    v_mfma_f32_32x32x16_bf16 v[40:55], v[144:147], v[160:163], v[40:55]
    ds_read_b64_tr_b16 v[108:109], v17 offset:0
    ds_read_b64_tr_b16 v[110:111], v17 offset:1536
    s_add_u32 m0, s40, 7168
    s_nop 0
    buffer_load_dwordx4 v13, s[12:15], s43 offen lds
    v_mfma_f32_32x32x16_bf16 v[72:87], v[148:151], v[160:163], v[72:87]
    ds_read_b64_tr_b16 v[112:113], v18 offset:0
    ds_read_b64_tr_b16 v[114:115], v18 offset:1536
    s_add_u32 m0, s40, 8192
    s_nop 0
    buffer_load_dwordx4 v14, s[12:15], s43 offen lds
    s_add_u32 s43, s43, s52
    s_sub_u32 s52, s48, s52
    v_mfma_f32_32x32x16_bf16 v[56:71], v[148:151], v[156:159], v[56:71]
    buffer_load_dwordx4 v[160:163], v19, s[20:23], s42 offen
    s_add_u32 s42, s42, 1024
    s_cmp_eq_u32 s35, 6
    s_cbranch_scc1 fps_135
fpsb_136:
    s_sub_u32 s34, s34, 1
    s_add_u32 s35, s35, 1
    s_cmp_lt_u32 s35, 9
    s_cselect_b32 s46, s34, 0
    v_mfma_f32_32x32x16_bf16 v[88:103], v[152:155], v[156:159], v[88:103]
    buffer_load_dwordx4 v[156:159], v19, s[20:23], s41 offen
    s_add_u32 s41, s41, 1024
    s_setprio 3
    s_add_u32 s40, s40, s33
    s_sub_u32 s33, 0, s33
    s_mov_b64 exec, 0x7fff
    buffer_load_dword v165, v21, s[4:7], s32 offen
    s_mov_b64 exec, -1
    s_add_u32 s32, s32, s31
    s_cmp_gt_u32 s46, 3
    s_cbranch_scc1 dfast_118
    s_branch dtop_103
dwo_113:
    ds_read_b64_tr_b16 v[124:125], v16 offset:3072
    ds_read_b64_tr_b16 v[126:127], v16 offset:4608
    ds_read_b64_tr_b16 v[128:129], v17 offset:3072
    ds_read_b64_tr_b16 v[130:131], v17 offset:4608
    ds_read_b64_tr_b16 v[132:133], v18 offset:3072
    ds_read_b64_tr_b16 v[134:135], v18 offset:4608
    ds_read_b64_tr_b16 v[144:145], v16 offset:6144
    ds_read_b64_tr_b16 v[146:147], v16 offset:7680
    ds_read_b64_tr_b16 v[148:149], v17 offset:6144
    ds_read_b64_tr_b16 v[150:151], v17 offset:7680
    ds_read_b64_tr_b16 v[152:153], v18 offset:6144
    ds_read_b64_tr_b16 v[154:155], v18 offset:7680
    s_mov_b32 s45, 0x15556
    s_waitcnt lgkmcnt(0)
    s_add_u32 m0, s39, 9216
    s_nop 0
    buffer_load_dwordx4 v12, s[12:15], s43 offen lds
    s_add_u32 m0, s39, 10240
    s_nop 0
    buffer_load_dwordx4 v13, s[12:15], s43 offen lds
    s_add_u32 m0, s39, 11264
    s_nop 0
    buffer_load_dwordx4 v14, s[12:15], s43 offen lds
    s_add_u32 s43, s43, s52
    s_sub_u32 s52, s48, s52
    s_add_u32 m0, s39, 12288
    s_nop 0
    buffer_load_dwordx4 v12, s[12:15], s43 offen lds
    s_add_u32 m0, s39, 13312
    s_nop 0
    buffer_load_dwordx4 v13, s[12:15], s43 offen lds
    s_add_u32 m0, s39, 14336
    s_nop 0
    buffer_load_dwordx4 v14, s[12:15], s43 offen lds
    s_add_u32 s43, s43, s52
    s_sub_u32 s52, s48, s52
    v_add_u32 v4, 0, v1
    v_mul_lo_u32 v5, v4, s45
    v_bfe_u32 v4, v5, 22, 1
    v_lshrrev_b32 v5, 23, v5
    v_mul_u32_u24 v4, 46080, v4
    v_mul_u32_u24 v5, 15360, v5
    v_add3_u32 v12, v12, v5, v4
    v_add_u32 v4, 64, v1
    v_mul_lo_u32 v5, v4, s45
    v_bfe_u32 v4, v5, 22, 1
    v_lshrrev_b32 v5, 23, v5
    v_mul_u32_u24 v4, 46080, v4
    v_mul_u32_u24 v5, 15360, v5
    v_add3_u32 v13, v13, v5, v4
    v_add_u32 v4, 128, v1
    v_mul_lo_u32 v5, v4, s45
    v_bfe_u32 v4, v5, 22, 1
    v_lshrrev_b32 v5, 23, v5
    v_mul_u32_u24 v4, 46080, v4
    v_mul_u32_u24 v5, 15360, v5
    v_add3_u32 v14, v14, v5, v4
    s_add_u32 s43, s56, 20480
    s_mov_b32 s52, 102400
    s_mov_b32 s48, 204800
    s_add_u32 m0, s39, 15360
    s_nop 0
    buffer_load_dwordx4 v12, s[12:15], s43 offen lds
    s_add_u32 m0, s39, 16384
    s_nop 0
    buffer_load_dwordx4 v13, s[12:15], s43 offen lds
    s_add_u32 m0, s39, 17408
    s_nop 0
    buffer_load_dwordx4 v14, s[12:15], s43 offen lds
    s_add_u32 s43, s43, s52
    s_sub_u32 s52, s48, s52
    s_add_u32 m0, s39, 18432
    s_nop 0
    buffer_load_dwordx4 v12, s[12:15], s43 offen lds
    s_add_u32 m0, s39, 19456
    s_nop 0
    buffer_load_dwordx4 v13, s[12:15], s43 offen lds
    s_add_u32 m0, s39, 20480
    s_nop 0
    buffer_load_dwordx4 v14, s[12:15], s43 offen lds
    s_add_u32 s43, s43, s52
    s_sub_u32 s52, s48, s52
    s_cmp_lg_u32 s34, 0
    s_cbranch_scc1 dnext_114
dend_106:
    v_subrev_u32 v16, 9216, v16
    v_subrev_u32 v17, 9216, v17
    v_subrev_u32 v18, 9216, v18
    s_mul_i32 s44, s26, 14336
    s_add_u32 s44, s44, 49152
    v_add_u32 v20, s44, v19
    v_and_b32 v4, 7, v3
    v_xor_b32 v4, v4, v2
    v_lshlrev_b32 v5, 7, v3
    v_add_u32 v5, s39, v5
    v_xor_b32 v6, 0, v4
    v_lshl_add_u32 v8, v6, 4, v5
    v_xor_b32 v6, 2, v4
    v_lshl_add_u32 v9, v6, 4, v5
    v_xor_b32 v6, 4, v4
    v_lshl_add_u32 v10, v6, 4, v5
    v_xor_b32 v6, 6, v4
    v_lshl_add_u32 v11, v6, 4, v5
    s_barrier
    s_mov_b32 s93, 200000
op_140:
    buffer_load_dwordx4 v[116:119], v19, s[20:23], s54 offen offset:0 sc1
    buffer_load_dwordx4 v[120:123], v19, s[20:23], s55 offen offset:0 sc1
    buffer_load_dwordx4 v[136:139], v19, s[20:23], s54 offen offset:1024 sc1
    buffer_load_dwordx4 v[140:143], v19, s[20:23], s55 offen offset:1024 sc1
    buffer_load_dwordx4 v[156:159], v19, s[20:23], s54 offen offset:2048 sc1
    buffer_load_dwordx4 v[160:163], v19, s[20:23], s55 offen offset:2048 sc1
    s_waitcnt vmcnt(0)
    v_max3_u32 v4, v116, v117, v118
    v_max3_u32 v4, v4, v119, v120
    v_max3_u32 v4, v4, v121, v122
    v_max3_u32 v4, v4, v123, v136
    v_max3_u32 v4, v4, v137, v138
    v_max3_u32 v4, v4, v139, v140
    v_max3_u32 v4, v4, v141, v142
    v_max3_u32 v4, v4, v143, v156
    v_max3_u32 v4, v4, v157, v158
    v_max3_u32 v4, v4, v159, v160
    v_max3_u32 v4, v4, v161, v162
    v_max_u32 v4, v4, v163
    v_cmp_eq_u32 vcc, -1, v4
    s_nop 1
    s_cmp_eq_u64 vcc, 0
    s_cbranch_scc1 opd_141
    s_sub_u32 s93, s93, 1
    s_cbranch_scc1 opd_141
    s_sleep 3
    s_branch op_140
opd_141:
    v_mfma_f32_32x32x16_bf16 v[24:39], v[104:107], v[116:119], v[24:39]
    v_mfma_f32_32x32x16_bf16 v[40:55], v[104:107], v[120:123], v[40:55]
    v_mfma_f32_32x32x16_bf16 v[56:71], v[108:111], v[116:119], v[56:71]
    v_mfma_f32_32x32x16_bf16 v[72:87], v[108:111], v[120:123], v[72:87]
    v_mfma_f32_32x32x16_bf16 v[88:103], v[112:115], v[116:119], v[88:103]
    ds_read_b64_tr_b16 v[104:105], v16 offset:0
    ds_read_b64_tr_b16 v[106:107], v16 offset:1536
    ds_read_b64_tr_b16 v[108:109], v17 offset:0
    ds_read_b64_tr_b16 v[110:111], v17 offset:1536
    ds_read_b64_tr_b16 v[112:113], v18 offset:0
    ds_read_b64_tr_b16 v[114:115], v18 offset:1536
    v_mfma_f32_32x32x16_bf16 v[24:39], v[124:127], v[136:139], v[24:39]
    v_mfma_f32_32x32x16_bf16 v[40:55], v[124:127], v[140:143], v[40:55]
    v_mfma_f32_32x32x16_bf16 v[56:71], v[128:131], v[136:139], v[56:71]
    v_mfma_f32_32x32x16_bf16 v[72:87], v[128:131], v[140:143], v[72:87]
    v_mfma_f32_32x32x16_bf16 v[88:103], v[132:135], v[136:139], v[88:103]
    ds_read_b64_tr_b16 v[124:125], v16 offset:3072
    ds_read_b64_tr_b16 v[126:127], v16 offset:4608
    ds_read_b64_tr_b16 v[128:129], v17 offset:3072
    ds_read_b64_tr_b16 v[130:131], v17 offset:4608
    ds_read_b64_tr_b16 v[132:133], v18 offset:3072
    ds_read_b64_tr_b16 v[134:135], v18 offset:4608
    v_mfma_f32_32x32x16_bf16 v[24:39], v[144:147], v[156:159], v[24:39]
    v_mfma_f32_32x32x16_bf16 v[40:55], v[144:147], v[160:163], v[40:55]
    v_mfma_f32_32x32x16_bf16 v[56:71], v[148:151], v[156:159], v[56:71]
    v_mfma_f32_32x32x16_bf16 v[72:87], v[148:151], v[160:163], v[72:87]
    v_mfma_f32_32x32x16_bf16 v[88:103], v[152:155], v[156:159], v[88:103]
    ds_read_b64_tr_b16 v[144:145], v16 offset:6144
    ds_read_b64_tr_b16 v[146:147], v16 offset:7680
    ds_read_b64_tr_b16 v[148:149], v17 offset:6144
    ds_read_b64_tr_b16 v[150:151], v17 offset:7680
    ds_read_b64_tr_b16 v[152:153], v18 offset:6144
    ds_read_b64_tr_b16 v[154:155], v18 offset:7680
    s_waitcnt lgkmcnt(0)
    s_barrier
    ds_read_b128 v[116:119], v20 offset:0
    ds_read_b128 v[120:123], v20 offset:1024
    ds_read_b128 v[136:139], v20 offset:2048
    ds_read_b128 v[140:143], v20 offset:3072
    ds_read_b128 v[156:159], v20 offset:4096
    ds_read_b128 v[160:163], v20 offset:5120
    s_waitcnt lgkmcnt(4)
    v_mfma_f32_32x32x16_bf16 v[24:39], v[104:107], v[116:119], v[24:39]
    v_mfma_f32_32x32x16_bf16 v[40:55], v[104:107], v[120:123], v[40:55]
    v_mfma_f32_32x32x16_bf16 v[56:71], v[108:111], v[116:119], v[56:71]
    v_mfma_f32_32x32x16_bf16 v[72:87], v[108:111], v[120:123], v[72:87]
    v_mfma_f32_32x32x16_bf16 v[88:103], v[112:115], v[116:119], v[88:103]
    ds_read_b64_tr_b16 v[104:105], v16 offset:9216
    ds_read_b64_tr_b16 v[106:107], v16 offset:10752
    ds_read_b64_tr_b16 v[108:109], v17 offset:9216
    ds_read_b64_tr_b16 v[110:111], v17 offset:10752
    ds_read_b64_tr_b16 v[112:113], v18 offset:9216
    ds_read_b64_tr_b16 v[114:115], v18 offset:10752
    ds_read_b128 v[116:119], v20 offset:6144
    ds_read_b128 v[120:123], v20 offset:7168
    s_waitcnt lgkmcnt(10)
    v_mfma_f32_32x32x16_bf16 v[24:39], v[124:127], v[136:139], v[24:39]
    v_mfma_f32_32x32x16_bf16 v[40:55], v[124:127], v[140:143], v[40:55]
    v_mfma_f32_32x32x16_bf16 v[56:71], v[128:131], v[136:139], v[56:71]
    v_mfma_f32_32x32x16_bf16 v[72:87], v[128:131], v[140:143], v[72:87]
    v_mfma_f32_32x32x16_bf16 v[88:103], v[132:135], v[136:139], v[88:103]
    ds_read_b64_tr_b16 v[124:125], v16 offset:12288
    ds_read_b64_tr_b16 v[126:127], v16 offset:13824
    ds_read_b64_tr_b16 v[128:129], v17 offset:12288
    ds_read_b64_tr_b16 v[130:131], v17 offset:13824
    ds_read_b64_tr_b16 v[132:133], v18 offset:12288
    ds_read_b64_tr_b16 v[134:135], v18 offset:13824
    ds_read_b128 v[136:139], v20 offset:8192
    ds_read_b128 v[140:143], v20 offset:9216
    s_waitcnt lgkmcnt(8)
    v_mfma_f32_32x32x16_bf16 v[24:39], v[144:147], v[156:159], v[24:39]
    v_mfma_f32_32x32x16_bf16 v[40:55], v[144:147], v[160:163], v[40:55]
    v_mfma_f32_32x32x16_bf16 v[56:71], v[148:151], v[156:159], v[56:71]
    v_mfma_f32_32x32x16_bf16 v[72:87], v[148:151], v[160:163], v[72:87]
    v_mfma_f32_32x32x16_bf16 v[88:103], v[152:155], v[156:159], v[88:103]
    ds_read_b64_tr_b16 v[144:145], v16 offset:15360
    ds_read_b64_tr_b16 v[146:147], v16 offset:16896
    ds_read_b64_tr_b16 v[148:149], v17 offset:15360
    ds_read_b64_tr_b16 v[150:151], v17 offset:16896
    ds_read_b64_tr_b16 v[152:153], v18 offset:15360
    ds_read_b64_tr_b16 v[154:155], v18 offset:16896
    ds_read_b128 v[156:159], v20 offset:10240
    ds_read_b128 v[160:163], v20 offset:11264
    s_waitcnt lgkmcnt(8)
    v_mfma_f32_32x32x16_bf16 v[24:39], v[104:107], v[116:119], v[24:39]
    v_mfma_f32_32x32x16_bf16 v[40:55], v[104:107], v[120:123], v[40:55]
    v_mfma_f32_32x32x16_bf16 v[56:71], v[108:111], v[116:119], v[56:71]
    v_mfma_f32_32x32x16_bf16 v[72:87], v[108:111], v[120:123], v[72:87]
    v_mfma_f32_32x32x16_bf16 v[88:103], v[112:115], v[116:119], v[88:103]
    ds_read_b64_tr_b16 v[104:105], v16 offset:18432
    ds_read_b64_tr_b16 v[106:107], v16 offset:19968
    ds_read_b64_tr_b16 v[108:109], v17 offset:18432
    ds_read_b64_tr_b16 v[110:111], v17 offset:19968
    ds_read_b64_tr_b16 v[112:113], v18 offset:18432
    ds_read_b64_tr_b16 v[114:115], v18 offset:19968
    ds_read_b128 v[116:119], v20 offset:12288
    ds_read_b128 v[120:123], v20 offset:13312
    s_cmp_ge_u32 s24, 10
    s_cbranch_scc1 g2o_142
    s_lshr_b32 s45, s24, 1
    s_and_b32 s46, s24, 1
    s_lshl_b32 s46, s46, 4
    v_lshrrev_b32 v12, 2, v1
    v_add_u32 v12, s46, v12
    v_and_b32 v13, 3, v1
    s_and_b32 s47, s45, 1
    s_cmp_eq_u32 s47, 1
    s_cselect_b32 s47, s60, s59
    s_mul_i32 s47, s47, 40960
    s_lshr_b32 s48, s45, 1
    s_add_u32 s49, s48, s58
    s_lshl_b32 s49, s49, 6
    s_lshl_b32 s50, s58, 7
    s_sub_u32 s50, 128, s50
    s_cmp_eq_u32 s48, 2
    s_cselect_b32 s49, s50, s49
    s_add_u32 s47, s47, s49
    s_add_u32 s31, s47, s61
    v_mul_u32_u24 v18, 1280, v12
    v_lshl_add_u32 v18, v13, 4, v18
    buffer_load_dwordx4 v[14:17], v18, s[8:11], s31 offen
    v_lshlrev_b32 v13, 1, v13
    v_and_b32 v19, 7, v12
    v_xor_b32 v13, v13, v19
    v_lshlrev_b32 v12, 7, v12
    v_lshl_add_u32 v12, v13, 4, v12
    s_lshl_b32 s47, s45, 12
    v_add_u32 v12, s47, v12
    v_xor_b32 v13, 16, v12
g2o_142:
    s_waitcnt lgkmcnt(0)
    v_mfma_f32_32x32x16_bf16 v[24:39], v[124:127], v[136:139], v[24:39]
    v_mfma_f32_32x32x16_bf16 v[24:39], v[144:147], v[156:159], v[24:39]
    v_mfma_f32_32x32x16_bf16 v[24:39], v[104:107], v[116:119], v[24:39]
    v_mfma_f32_32x32x16_bf16 v[40:55], v[124:127], v[140:143], v[40:55]
    v_mfma_f32_32x32x16_bf16 v[40:55], v[144:147], v[160:163], v[40:55]
    v_mfma_f32_32x32x16_bf16 v[40:55], v[104:107], v[120:123], v[40:55]
    v_mfma_f32_32x32x16_bf16 v[56:71], v[128:131], v[136:139], v[56:71]
    v_mfma_f32_32x32x16_bf16 v[56:71], v[148:151], v[156:159], v[56:71]
    v_mfma_f32_32x32x16_bf16 v[56:71], v[108:111], v[116:119], v[56:71]
    s_nop 5
    ds_write_b128 v8, v[24:27] offset:0
    ds_write_b128 v9, v[28:31] offset:0
    ds_write_b128 v10, v[32:35] offset:0
    ds_write_b128 v11, v[36:39] offset:0
    v_mfma_f32_32x32x16_bf16 v[72:87], v[128:131], v[140:143], v[72:87]
    v_mfma_f32_32x32x16_bf16 v[72:87], v[148:151], v[160:163], v[72:87]
    v_mfma_f32_32x32x16_bf16 v[72:87], v[108:111], v[120:123], v[72:87]
    s_nop 5
    ds_write_b128 v8, v[40:43] offset:4096
    ds_write_b128 v9, v[44:47] offset:4096
    ds_write_b128 v10, v[48:51] offset:4096
    ds_write_b128 v11, v[52:55] offset:4096
    v_mfma_f32_32x32x16_bf16 v[88:103], v[132:135], v[136:139], v[88:103]
    v_mfma_f32_32x32x16_bf16 v[88:103], v[152:155], v[156:159], v[88:103]
    v_mfma_f32_32x32x16_bf16 v[88:103], v[112:115], v[116:119], v[88:103]
    s_nop 5
    ds_write_b128 v8, v[56:59] offset:8192
    ds_write_b128 v9, v[60:63] offset:8192
    ds_write_b128 v10, v[64:67] offset:8192
    ds_write_b128 v11, v[68:71] offset:8192
    s_nop 3
    ds_write_b128 v8, v[72:75] offset:12288
    ds_write_b128 v9, v[76:79] offset:12288
    ds_write_b128 v10, v[80:83] offset:12288
    ds_write_b128 v11, v[84:87] offset:12288
    s_nop 3
    ds_write_b128 v8, v[88:91] offset:16384
    ds_write_b128 v9, v[92:95] offset:16384
    ds_write_b128 v10, v[96:99] offset:16384
    ds_write_b128 v11, v[100:103] offset:16384
    s_waitcnt vmcnt(0) lgkmcnt(0)
    s_barrier
    v_mov_b32 v24, v12
    v_mov_b32 v25, v13
    v_mov_b32 v26, v14
    v_mov_b32 v27, v15
    v_mov_b32 v28, v16
    v_mov_b32 v29, v17
    v_mov_b32 v30, v18
    v_mov_b32 v31, v19
    s_cmp_ge_u32 s24, 10
    s_cbranch_scc1 g2o_143
    ds_read_b128 v[32:35], v24 offset:0
    ds_read_b128 v[36:39], v25 offset:0
    ds_read_b128 v[40:43], v24 offset:21504
    ds_read_b128 v[44:47], v25 offset:21504
    v_add_u32 v24, 106496, v24
    v_add_u32 v25, 106496, v25
    ds_read_b128 v[48:51], v24 offset:0
    ds_read_b128 v[52:55], v25 offset:0
    ds_read_b128 v[56:59], v24 offset:21504
    ds_read_b128 v[60:63], v25 offset:21504
    s_waitcnt vmcnt(0)
    v_lshlrev_b32 v64, 16, v26
    v_and_b32 v65, 0xffff0000, v26
    v_lshlrev_b32 v66, 16, v27
    v_and_b32 v67, 0xffff0000, v27
    v_lshlrev_b32 v68, 16, v28
    v_and_b32 v69, 0xffff0000, v28
    v_lshlrev_b32 v70, 16, v29
    v_and_b32 v71, 0xffff0000, v29
    s_waitcnt lgkmcnt(4)
    v_pk_add_f32 v[32:33], v[32:33], v[40:41]
    v_pk_add_f32 v[34:35], v[34:35], v[42:43]
    v_pk_add_f32 v[36:37], v[36:37], v[44:45]
    v_pk_add_f32 v[38:39], v[38:39], v[46:47]
    v_pk_add_f32 v[32:33], v[32:33], v[64:65]
    v_pk_add_f32 v[34:35], v[34:35], v[66:67]
    v_pk_add_f32 v[36:37], v[36:37], v[68:69]
    v_pk_add_f32 v[38:39], v[38:39], v[70:71]
    s_waitcnt lgkmcnt(0)
    v_pk_add_f32 v[48:49], v[48:49], v[56:57]
    v_pk_add_f32 v[50:51], v[50:51], v[58:59]
    v_pk_add_f32 v[52:53], v[52:53], v[60:61]
    v_pk_add_f32 v[54:55], v[54:55], v[62:63]
    v_pk_add_f32 v[32:33], v[32:33], v[48:49]
    v_pk_add_f32 v[34:35], v[34:35], v[50:51]
    v_pk_add_f32 v[36:37], v[36:37], v[52:53]
    v_pk_add_f32 v[38:39], v[38:39], v[54:55]
    v_cvt_pk_bf16_f32 v40, v32, v33
    v_cvt_pk_bf16_f32 v41, v34, v35
    v_cvt_pk_bf16_f32 v42, v36, v37
    v_cvt_pk_bf16_f32 v43, v38, v39
    buffer_store_dwordx4 v[40:43], v30, s[64:67], s31 offen
g2o_143:
end_1:
    s_endpgm
.section .rodata,"a"
.p2align 6
.amdhsa_kernel parallel_sum__grouped_kv_mqa__geglu_ffn__prompt_kernel
  .amdhsa_next_free_vgpr 168
  .amdhsa_next_free_sgpr 102
  .amdhsa_accum_offset 168
  .amdhsa_group_segment_fixed_size 0
  .amdhsa_kernarg_size 96
  .amdhsa_user_sgpr_count 2
  .amdhsa_user_sgpr_kernarg_segment_ptr 1
  .amdhsa_system_sgpr_workgroup_id_x 1
.end_amdhsa_kernel
```
